```python
import torch

def _softmax(x, axis=-1):
    return torch.softmax(x, dim=axis)
def _gelu(x):
    return torch.nn.functional.gelu(x, approximate="tanh")
def _silu(x):
    return torch.nn.functional.silu(x)
def _sigmoid(x):
    return torch.sigmoid(x)
def _layernorm(x, axis=-1, eps=1e-5):
    m = x.mean(dim=axis, keepdim=True)
    v = x.var(dim=axis, keepdim=True, unbiased=False)
    return (x - m) / torch.sqrt(v + eps)
def _scatter_add(tgt, idx, src, axis=0):
    return tgt.clone().index_add_(axis, idx, src)
def _segment_sum(src, seg, n):
    out = torch.zeros((n,) + src.shape[1:], dtype=src.dtype)
    return out.index_add_(0, seg, src)
def _pad(x, pw):
    flat = tuple(v for pair in reversed(pw) for v in pair)
    return torch.nn.functional.pad(x, flat)

kernel_name = 'gated_mix__compressed_kv_cla__sliding_block_cached__decode'

def setup_inputs():

    _w = (lambda a: (lambda t: t.to(torch.bfloat16) if t.is_floating_point() else t)(torch.as_tensor(a)))
    def _A_setup():
        B, H, Sq, Sk, D, M = 8, 32, 1, 4096, 128, 512
        Dc = 4 * D
        return {
            "x": _w((lambda *s: torch.randn(*s, dtype=torch.bfloat16) * 0.05)(B, Sq, M)),
            "c_kv": _w((lambda *s: torch.randn(*s, dtype=torch.bfloat16) * 0.4)(B, Sk, Dc)),
            "w_q": _w((lambda *s: torch.randn(*s, dtype=torch.bfloat16) * 6.4)(M, H, D) * (M ** -0.5)),
            "w_uk": _w((lambda *s: torch.randn(*s, dtype=torch.bfloat16) * 6.4)(Dc, H, D) * (Dc ** -0.5)),
            "w_uv": _w((lambda *s: torch.randn(*s, dtype=torch.bfloat16) * 0.4)(Dc, H, D) * (Dc ** -0.5)),
            "w_o": _w((lambda *s: torch.randn(*s, dtype=torch.bfloat16) * 0.4)(H, D, M) * ((H * D) ** -0.5)),
        }
    _A_in = _A_setup()

    def _B_setup():
        B, Sq, D = 8, 1, 512
        Hq, Hkv, Sk, Dh = 32, 8, 4096, 128
        assert Hq % Hkv == 0, (Hq, Hkv)
        return {
            "x": _w((lambda *s: torch.randn(*s, dtype=torch.bfloat16) * 0.05)(B, Sq, D)),
            "k_cache": _w((lambda *s: torch.randn(*s, dtype=torch.bfloat16) * 6.4)(B, Hkv, Sk, Dh)),
            "v_cache": _w((lambda *s: torch.randn(*s, dtype=torch.bfloat16) * 0.05)(B, Hkv, Sk, Dh)),
            "wq": _w((lambda *s: torch.randn(*s, dtype=torch.bfloat16) * 6.4)(D, Hq * Dh) * (D ** -0.5)),
            "wo": _w((lambda *s: torch.randn(*s, dtype=torch.bfloat16) * 0.05)(Hq * Dh, D) * ((Hq * Dh) ** -0.5)),
        }
    _B_in = _B_setup()

    return {
        "A_x": _A_in["x"],
        "A_c_kv": _A_in["c_kv"],
        "A_w_q": _A_in["w_q"],
        "A_w_uk": _A_in["w_uk"],
        "A_w_uv": _A_in["w_uv"],
        "A_w_o": _A_in["w_o"],
        "B_x": _B_in["x"],
        "B_k_cache": _B_in["k_cache"],
        "B_v_cache": _B_in["v_cache"],
        "B_wq": _B_in["wq"],
        "B_wo": _B_in["wo"],
        "gate_w": _w((lambda *s: torch.randn(*s, dtype=torch.bfloat16) * 0.05)(512) * 16.0),
    }

def reference(A_x, A_c_kv, A_w_q, A_w_uk, A_w_uv, A_w_o, B_x, B_k_cache, B_v_cache, B_wq, B_wo, gate_w):
    def _A_ref(x, c_kv, w_q, w_uk, w_uv, w_o):
        B, Sq, M = x.shape[0], x.shape[1], x.shape[2]
        Sk = c_kv.shape[1]
        H, D = w_q.shape[1], w_q.shape[2]
        q = torch.einsum("bqm,mhd->bhqd", x, w_q)
        k = torch.einsum("bkc,chd->bhkd", c_kv, w_uk)
        v = torch.einsum("bkc,chd->bhkd", c_kv, w_uv)
        scores = torch.einsum("bhqd,bhkd->bhqk", q, k) * (D ** -0.5)
        off = Sk - Sq
        qi = torch.arange(Sq)[:, None]
        kj = torch.arange(Sk)[None, :]
        cmask = kj <= (qi + off)
        scores = torch.where(cmask[None, None], scores, -1e9)
        p = _softmax(scores, axis=-1)
        ctx = torch.einsum("bhqk,bhkd->bhqd", p, v)
        return torch.einsum("bhqd,hdm->bqm", ctx, w_o)

    def _B_ref(x, k_cache, v_cache, wq, wo):
        B, Sq, D = x.shape
        Hq, Dh = 32, 128
        Hkv, Sk = k_cache.shape[1], k_cache.shape[2]
        W = min(4096, max(256, Sk // 4))
        rep = Hq // Hkv
        q = (lambda x, *d: x.permute(*d))((x @ wq).reshape(B, Sq, Hq, Dh), 0, 2, 1, 3)
        k = (lambda x, n, axis: torch.repeat_interleave(x, n, dim=axis))(k_cache[:, :, Sk - W:, :], rep, axis=1)
        v = (lambda x, n, axis: torch.repeat_interleave(x, n, dim=axis))(v_cache[:, :, Sk - W:, :], rep, axis=1)
        scores = torch.einsum("bhqd,bhkd->bhqk", q, k) * (Dh ** -0.5)
        p = _softmax(scores, axis=-1)
        o = torch.einsum("bhqk,bhkd->bhqd", p, v)
        return (lambda x, *d: x.permute(*d))(o, 0, 2, 1, 3).reshape(B, Sq, Hq * Dh) @ wo

    x = A_x
    g = _sigmoid((x * gate_w).sum(-1, keepdims=True))
    a = _A_ref(x, A_c_kv, A_w_q, A_w_uk, A_w_uv, A_w_o)
    b = _B_ref(x, B_k_cache, B_v_cache, B_wq, B_wo)
    return g * a + (1 - g) * b
```

```asm
; @launch grid=(256,1,1) block=(512,1,1) lds=163840
.amdgcn_target "amdgcn-amd-amdhsa--gfx950"
.text
.globl gated_mix__compressed_kv_cla__sliding_block_cached__decode_kernel
.p2align 8
.type gated_mix__compressed_kv_cla__sliding_block_cached__decode_kernel,@function
gated_mix__compressed_kv_cla__sliding_block_cached__decode_kernel:
    s_cmp_ge_u32 s2, 256
    s_cbranch_scc1 L_end
    s_load_dwordx16 s[4:19], s[0:1], 0
    s_load_dwordx8 s[20:27], s[0:1], 64
    s_load_dwordx4 s[28:31], s[0:1], 96
    s_load_dwordx2 s[32:33], s[0:1], 112
    v_lshrrev_b32 v1, 6, v0
    v_and_b32 v0, 63, v0
    v_readfirstlane_b32 s34, v1
    s_and_b32 s35, s2, 7
    s_lshr_b32 s36, s2, 4
    s_lshr_b32 s37, s36, 2
    s_lshl_b32 s3, s35, 2
    s_add_u32 s37, s37, s3
    s_and_b32 s38, s36, 3
    s_lshl_b32 s39, s36, 3
    s_or_b32 s39, s39, s35
    v_lshrrev_b32 v1, 4, v0
    v_and_b32 v2, 15, v0
    v_bfe_u32 v3, v0, 2, 2
    v_and_b32 v4, 3, v0
    v_and_b32 v5, 7, v0
    s_mov_b32 s78, 0xff00ff00
    s_mov_b32 s79, 0xff00ff00
    s_mov_b32 s100, 0x00010001
    s_mov_b32 s101, 0xff
    s_mov_b32 s98, 0x05040100
    s_mov_b32 s99, 0x07060302
    s_mov_b32 s77, 20000
    s_waitcnt lgkmcnt(0)
    s_load_dword s76, s[32:33], 0
    s_mov_b32 s40, s32
    s_mov_b32 s41, s33
    s_mov_b32 s42, 7864320
    s_mov_b32 s43, 0x20000
    s_mov_b32 s44, s4
    s_mov_b32 s45, s5
    s_mov_b32 s46, 8192
    s_mov_b32 s47, 0x20000
    s_bitcmp1_b32 s2, 3
    s_cbranch_scc1 L_B
    s_lshl_b32 s3, s37, 8
    s_lshl_b32 s4, s38, 20
    s_add_u32 s3, s3, s4
    s_add_u32 s48, s8, s3
    s_addc_u32 s49, s9, 0
    s_mov_b32 s50, 1040640
    s_mov_b32 s51, 0x20000
    v_lshlrev_b32 v22, 1, v1
    v_xor_b32 v22, v22, v2
    v_lshlrev_b32 v22, 4, v22
    v_lshl_add_u32 v6, v1, 13, v22
    v_xor_b32 v7, 128, v6
    s_lshl_b32 s13, s34, 17
    s_lshl_b32 s14, s34, 12
    s_add_u32 m0, s14, 98304
    s_mov_b32 s15, s13
    buffer_load_dwordx4 v6, s[48:51], s15 offen nt lds
    s_add_u32 m0, m0, 1024
    s_add_u32 s15, s15, 0x8000
    buffer_load_dwordx4 v6, s[48:51], s15 offen nt lds
    s_add_u32 m0, m0, 1024
    s_add_u32 s15, s15, 0x8000
    buffer_load_dwordx4 v7, s[48:51], s15 offen nt lds
    s_add_u32 m0, m0, 1024
    s_add_u32 s15, s15, 0x8000
    buffer_load_dwordx4 v7, s[48:51], s15 offen nt lds
    s_add_u32 s52, s10, s3
    s_addc_u32 s53, s11, 0
    s_mov_b32 s54, 1040640
    s_mov_b32 s55, 0x20000
    v_lshlrev_b32 v20, 10, v5
    v_lshl_add_u32 v20, v1, 4, v20
    s_lshl_b32 s3, s38, 8
    buffer_load_dwordx4 v[32:35], v20, s[44:47], s3 offen offset:0
    buffer_load_dwordx4 v[36:39], v20, s[44:47], s3 offen offset:64
    buffer_load_dwordx4 v[40:43], v20, s[44:47], s3 offen offset:128
    buffer_load_dwordx4 v[44:47], v20, s[44:47], s3 offen offset:192
    v_bfe_u32 v23, v0, 3, 1
    v_lshlrev_b32 v23, 6, v23
    v_lshl_add_u32 v23, v1, 4, v23
    v_lshl_add_u32 v21, v5, 13, v23
    s_add_u32 s15, s13, 0x10000
    buffer_load_dwordx4 v[48:51], v21, s[52:55], s13 offen offset:0 nt
    buffer_load_dwordx4 v[52:55], v21, s[52:55], s13 offen offset:128 nt
    buffer_load_dwordx4 v[56:59], v21, s[52:55], s15 offen offset:0 nt
    buffer_load_dwordx4 v[60:63], v21, s[52:55], s15 offen offset:128 nt
    s_lshl_b32 s3, s35, 22
    s_lshl_b32 s4, s36, 18
    s_add_u32 s3, s3, s4
    s_add_u32 s56, s6, s3
    s_addc_u32 s57, s7, 0
    s_mov_b32 s58, 262144
    s_mov_b32 s59, 0x20000
    s_mov_b32 s60, s28
    s_mov_b32 s61, s29
    s_mov_b32 s62, 8192
    s_mov_b32 s63, 0x20000
    s_and_b32 s4, s34, 3
    s_lshr_b32 s5, s34, 2
    s_lshl_b32 s6, s34, 12
    s_lshl_b32 s7, s35, 4
    s_add_u32 s7, s7, s36
    v_xor_b32 v8, s4, v0
    v_lshlrev_b32 v8, 4, v8
    v_xor_b32 v9, 64, v8
    v_xor_b32 v10, 128, v8
    v_xor_b32 v11, 192, v8
    v_and_b32 v12, 1, v1
    v_lshl_or_b32 v13, v12, 2, v3
    v_xor_b32 v13, s34, v13
    v_lshlrev_b32 v13, 5, v13
    v_lshl_add_u32 v12, v12, 3, v3
    v_lshl_add_u32 v13, v12, 8, v13
    v_lshrrev_b32 v12, 1, v1
    v_lshl_add_u32 v13, v12, 12, v13
    v_lshl_add_u32 v12, v4, 3, v13
    v_add_u32 v12, 98304, v12
    v_lshlrev_b32 v13, 11, v5
    v_lshl_add_u32 v13, v1, 4, v13
    s_lshl_b32 s9, s37, 14
    s_add_u32 s9, s9, 524288
    s_lshl_b32 s8, s38, 9
    s_add_u32 s8, s8, s9
    s_lshl_b32 s3, s34, 6
    s_add_u32 s8, s8, s3
    s_lshl_b32 s3, s34, 11
    s_add_u32 s9, s9, s3
    v_lshlrev_b32 v14, 4, v0
    s_mul_i32 s3, s34, 288
    s_add_u32 s3, s3, 148480
    v_and_b32 v24, 31, v0
    v_lshl_add_u32 v24, v24, 3, s3
    v_lshrrev_b32 v25, 5, v0
    v_lshl_add_u32 v24, v25, 2, v24
    v_mul_u32_u24 v25, 288, v5
    v_add3_u32 v25, v25, v23, s3
    s_mul_i32 s3, s34, 288
    v_subrev_u32 v25, s3, v25
    s_waitcnt lgkmcnt(0)
    s_add_u32 s76, s76, 1
    s_and_b32 s3, s76, 2
    s_lshl_b32 s3, s3, 15
    s_and_b32 s13, s76, 1
    s_or_b32 s3, s3, s13
    v_mov_b32 v30, s3
    v_mov_b32 v31, s76
    s_waitcnt vmcnt(8)
    s_barrier
    ds_read_b64_tr_b16 v[64:65], v12 offset:0
    ds_read_b64_tr_b16 v[66:67], v12 offset:1024
    ds_read_b64_tr_b16 v[68:69], v12 offset:8192
    ds_read_b64_tr_b16 v[70:71], v12 offset:9216
    ds_read_b64_tr_b16 v[72:73], v12 offset:16384
    ds_read_b64_tr_b16 v[74:75], v12 offset:17408
    ds_read_b64_tr_b16 v[76:77], v12 offset:24576
    ds_read_b64_tr_b16 v[78:79], v12 offset:25600
    s_waitcnt vmcnt(4)
    s_waitcnt lgkmcnt(6)
    v_mfma_f32_16x16x32_bf16 v[96:99], v[64:67], v[32:35], 0
    s_waitcnt lgkmcnt(4)
    v_mfma_f32_16x16x32_bf16 v[100:103], v[68:71], v[36:39], 0
    s_waitcnt lgkmcnt(2)
    v_mfma_f32_16x16x32_bf16 v[96:99], v[72:75], v[40:43], v[96:99]
    s_waitcnt lgkmcnt(0)
    v_mfma_f32_16x16x32_bf16 v[100:103], v[76:79], v[44:47], v[100:103]
    s_nop 7
    v_pk_add_f32 v[96:97], v[96:97], v[100:101]
    v_pk_add_f32 v[98:99], v[98:99], v[102:103]
    v_bfi_b32 v96, s101, v31, v96
    v_bfi_b32 v97, s101, v31, v97
    v_bfi_b32 v98, s101, v31, v98
    v_bfi_b32 v99, s101, v31, v99
    s_not_b64 exec, s[78:79]
    buffer_store_dwordx4 v[96:99], v13, s[40:43], s8 offen sc1
    s_mov_b64 exec, -1
    s_waitcnt vmcnt(0)
    buffer_load_dwordx4 v[64:67], v14, s[40:43], s9 offen offset:0 sc1
    buffer_load_dwordx4 v[68:71], v14, s[40:43], s9 offen offset:1024 sc1
    s_waitcnt vmcnt(0)
CHK_1:
    v_bitop3_b32 v72, v64, v65, v31 bitop3:0x7e
    v_bitop3_b32 v73, v66, v67, v31 bitop3:0x7e
    v_bitop3_b32 v74, v68, v69, v31 bitop3:0x7e
    v_or3_b32 v72, v72, v73, v74
    v_bitop3_b32 v73, v70, v71, v31 bitop3:0x7e
    v_or_b32 v72, v72, v73
    v_and_b32 v72, s101, v72
    v_cmp_ne_u32 vcc, 0, v72
    s_nop 0
    s_cbranch_vccz DONE_2
    s_cmp_eq_u32 s77, 0
    s_cbranch_scc1 DONE_2
    s_sub_u32 s77, s77, 1
    buffer_load_dwordx4 v[64:67], v14, s[40:43], s9 offen offset:0 sc1
    buffer_load_dwordx4 v[68:71], v14, s[40:43], s9 offen offset:1024 sc1
    s_waitcnt vmcnt(0)
    s_branch CHK_1
DONE_2:
    v_pk_add_f32 v[64:65], v[64:65], v[68:69]
    v_pk_add_f32 v[66:67], v[66:67], v[70:71]
    s_nop 1
    v_permlane32_swap_b32 v64, v66
    v_permlane32_swap_b32 v65, v67
    v_pk_add_f32 v[64:65], v[64:65], v[66:67]
    v_cvt_pk_bf16_f32 v64, v64, v65
    ds_write_b32 v24, v64
    s_waitcnt lgkmcnt(0)
    s_barrier
    ds_read_b128 v[64:67], v25 offset:0
    ds_read_b128 v[68:71], v25 offset:128
    s_lshl_b32 s3, s37, 10
    s_lshl_b32 s13, s38, 8
    s_add_u32 s3, s3, s13
    s_lshl_b32 s13, s34, 15
    s_add_u32 s3, s3, s13
    s_add_u32 s3, s3, 65536
    v_mov_b32 v23, 0x3e0293ee
    s_lshl_b32 s13, s34, 5
    s_add_u32 s13, s13, 131072
    v_mul_u32_u24 v22, 272, v5
    v_lshl_add_u32 v22, v1, 3, v22
    v_add_u32 v22, s13, v22
    s_mul_i32 s13, s34, 272
    s_add_u32 s13, s13, 131072
    v_lshlrev_b32 v26, 4, v2
    v_add_u32 v27, s13, v26
    s_waitcnt lgkmcnt(1)
    v_mfma_f32_16x16x32_bf16 v[96:99], v[48:51], v[64:67], 0
    v_mfma_f32_16x16x32_bf16 v[100:103], v[56:59], v[64:67], 0
    s_waitcnt lgkmcnt(0)
    v_mfma_f32_16x16x32_bf16 v[96:99], v[52:55], v[68:71], v[96:99]
    v_mfma_f32_16x16x32_bf16 v[100:103], v[60:63], v[68:71], v[100:103]
    s_nop 7
    v_permlane32_swap_b32 v96, v100
    v_permlane32_swap_b32 v97, v101
    v_permlane32_swap_b32 v98, v102
    v_permlane32_swap_b32 v99, v103
    v_add_f32_dpp v96, v100, v96 row_ror:8 row_mask:0xf bank_mask:0xf
    v_add_f32_dpp v97, v101, v97 row_ror:8 row_mask:0xf bank_mask:0xf
    v_add_f32_dpp v98, v102, v98 row_ror:8 row_mask:0xf bank_mask:0xf
    v_add_f32_dpp v99, v103, v99 row_ror:8 row_mask:0xf bank_mask:0xf
    v_mul_f32 v96, v23, v96
    v_mul_f32 v97, v23, v97
    v_mul_f32 v98, v23, v98
    v_mul_f32 v99, v23, v99
    v_perm_b32 v96, v97, v96, s99
    v_bfi_b32 v96, s100, v30, v96
    v_perm_b32 v97, v99, v98, s99
    v_bfi_b32 v97, s100, v30, v97
    s_not_b64 exec, s[78:79]
    ds_write_b64 v22, v[96:97]
    s_mov_b64 exec, 0xffff
    s_waitcnt lgkmcnt(0)
    s_barrier
    ds_read_b128 v[96:99], v27
    s_waitcnt lgkmcnt(0)
    buffer_store_dwordx4 v[96:99], v26, s[40:43], s3 offen sc1
    s_mov_b64 exec, -1
    s_lshl_b32 s13, s35, 15
    s_add_u32 s13, s13, s6
    s_add_u32 s13, s13, 65536
    v_lshl_or_b32 v22, v4, 2, v3
    v_lshlrev_b32 v23, 2, v1
    v_xor_b32 v22, v22, v23
    v_lshlrev_b32 v22, 4, v22
    v_lshl_add_u32 v22, v2, 10, v22
    s_lshl_b32 s3, s4, 14
    v_add_u32 v12, s3, v22
    s_lshl_b32 s3, s5, 14
    s_add_u32 s3, s3, 131072
    v_add_u32 v24, s3, v22
    v_xor_b32 v13, 16, v12
    v_xor_b32 v25, 16, v24
    v_xor_b32 v14, 32, v12
    v_xor_b32 v26, 32, v24
    v_xor_b32 v15, 48, v12
    v_xor_b32 v27, 48, v24
    v_lshrrev_b32 v22, 5, v0
    v_and_b32 v23, 1, v1
    v_lshrrev_b32 v28, 1, v4
    v_lshl_or_b32 v23, v23, 1, v28
    s_lshl_b32 s3, s34, 3
    v_or_b32 v23, s3, v23
    v_lshlrev_b32 v28, 1, v22
    v_lshl_or_b32 v28, v3, 2, v28
    v_xor_b32 v23, v23, v28
    v_lshlrev_b32 v23, 4, v23
    v_lshl_add_u32 v28, v22, 3, v3
    v_lshl_add_u32 v23, v28, 10, v23
    v_and_b32 v28, 1, v4
    v_lshl_add_u32 v16, v28, 3, v23
    v_xor_b32 v17, 16, v16
    v_xor_b32 v18, 64, v16
    v_xor_b32 v19, 80, v16
    s_lshl_b32 s3, s5, 4
    v_add_u32 v28, s3, v2
    v_mul_u32_u24 v6, 144, v28
    v_lshl_add_u32 v6, v1, 3, v6
    s_lshl_b32 s3, s4, 5
    s_add_u32 s3, s3, 131072
    v_add_u32 v6, s3, v6
    v_lshlrev_b32 v20, 4, v28
    v_add_u32 v20, 135680, v20
    v_and_b32 v28, 31, v0
    v_mul_u32_u24 v7, 144, v28
    v_lshl_add_u32 v7, v22, 4, v7
    v_add_u32 v7, 131072, v7
    v_lshlrev_b32 v21, 4, v28
    v_add_u32 v21, 135680, v21
    s_lshl_b32 s3, s4, 2
    v_add_u32 v29, s3, v20
    v_lshl_add_u32 v62, v0, 4, s6
    v_add_u32 v63, 0x10000, v62
    v_add_u32 v28, 131072, v62
    s_barrier
    s_add_u32 m0, s6, 0
    s_add_u32 s3, s6, 0
    buffer_load_dwordx4 v8, s[56:59], s3 offen offset:0 nt lds
    buffer_load_dwordx4 v9, s[56:59], s3 offen offset:1024 nt lds
    buffer_load_dwordx4 v10, s[56:59], s3 offen offset:2048 nt lds
    buffer_load_dwordx4 v11, s[56:59], s3 offen offset:3072 nt lds
    s_barrier
    s_add_u32 m0, s6, 32768
    s_add_u32 s3, s6, 32768
    buffer_load_dwordx4 v8, s[56:59], s3 offen offset:0 nt lds
    buffer_load_dwordx4 v9, s[56:59], s3 offen offset:1024 nt lds
    buffer_load_dwordx4 v10, s[56:59], s3 offen offset:2048 nt lds
    buffer_load_dwordx4 v11, s[56:59], s3 offen offset:3072 nt lds
    s_barrier
    buffer_load_dwordx4 v[32:35], v8, s[40:43], s13 offen offset:0 sc1
    buffer_load_dwordx4 v[36:39], v9, s[40:43], s13 offen offset:1024 sc1
    buffer_load_dwordx4 v[40:43], v10, s[40:43], s13 offen offset:2048 sc1
    s_waitcnt vmcnt(11)
    buffer_load_dwordx4 v[44:47], v11, s[40:43], s13 offen offset:3072 sc1
    s_waitcnt vmcnt(11)
    s_barrier
    s_add_u32 m0, s6, 65536
    s_add_u32 s3, s6, 65536
    buffer_load_dwordx4 v8, s[56:59], s3 offen offset:0 nt lds
    s_waitcnt vmcnt(11)
    buffer_load_dwordx4 v9, s[56:59], s3 offen offset:1024 nt lds
    s_waitcnt vmcnt(11)
    buffer_load_dwordx4 v10, s[56:59], s3 offen offset:2048 nt lds
    s_waitcnt vmcnt(11)
    buffer_load_dwordx4 v11, s[56:59], s3 offen offset:3072 nt lds
    s_waitcnt vmcnt(4)
CHK_3:
    v_bitop3_b32 v48, v32, v33, v30 bitop3:0x7e
    v_bitop3_b32 v49, v34, v35, v30 bitop3:0x7e
    v_bitop3_b32 v50, v36, v37, v30 bitop3:0x7e
    v_or3_b32 v48, v48, v49, v50
    v_bitop3_b32 v49, v38, v39, v30 bitop3:0x7e
    v_bitop3_b32 v50, v40, v41, v30 bitop3:0x7e
    v_or3_b32 v48, v48, v49, v50
    v_bitop3_b32 v49, v42, v43, v30 bitop3:0x7e
    v_bitop3_b32 v50, v44, v45, v30 bitop3:0x7e
    v_or3_b32 v48, v48, v49, v50
    v_bitop3_b32 v49, v46, v47, v30 bitop3:0x7e
    v_or_b32 v48, v48, v49
    v_and_b32 v48, s100, v48
    v_cmp_ne_u32 vcc, 0, v48
    s_nop 0
    s_cbranch_vccz DONE_4
    s_cmp_eq_u32 s77, 0
    s_cbranch_scc1 DONE_4
    s_sub_u32 s77, s77, 1
    buffer_load_dwordx4 v[32:35], v8, s[40:43], s13 offen offset:0 sc1
    buffer_load_dwordx4 v[36:39], v9, s[40:43], s13 offen offset:1024 sc1
    buffer_load_dwordx4 v[40:43], v10, s[40:43], s13 offen offset:2048 sc1
    buffer_load_dwordx4 v[44:47], v11, s[40:43], s13 offen offset:3072 sc1
    s_waitcnt vmcnt(0)
    s_branch CHK_3
DONE_4:
    v_or_b32 v32, s100, v32
    v_or_b32 v33, s100, v33
    v_or_b32 v34, s100, v34
    v_or_b32 v35, s100, v35
    v_or_b32 v36, s100, v36
    v_or_b32 v37, s100, v37
    v_or_b32 v38, s100, v38
    v_or_b32 v39, s100, v39
    v_or_b32 v40, s100, v40
    v_or_b32 v41, s100, v41
    v_or_b32 v42, s100, v42
    v_or_b32 v43, s100, v43
    v_or_b32 v44, s100, v44
    v_or_b32 v45, s100, v45
    v_or_b32 v46, s100, v46
    v_or_b32 v47, s100, v47
    ds_write_b128 v28, v[32:35] offset:0
    ds_write_b128 v28, v[36:39] offset:1024
    ds_write_b128 v28, v[40:43] offset:2048
    ds_write_b128 v28, v[44:47] offset:3072
    s_waitcnt lgkmcnt(0)
    s_barrier
    ds_read_b128 v[64:67], v24 offset:0
    ds_read_b128 v[68:71], v25 offset:0
    ds_read_b128 v[72:75], v26 offset:0
    ds_read_b128 v[76:79], v27 offset:0
    ds_read_b128 v[80:83], v24 offset:256
    ds_read_b128 v[84:87], v25 offset:256
    ds_read_b128 v[88:91], v26 offset:256
    ds_read_b128 v[92:95], v27 offset:256
    ds_read_b128 v[96:99], v24 offset:512
    ds_read_b128 v[100:103], v25 offset:512
    ds_read_b128 v[104:107], v26 offset:512
    ds_read_b128 v[108:111], v27 offset:512
    ds_read_b128 v[112:115], v24 offset:768
    ds_read_b128 v[116:119], v25 offset:768
    ds_read_b128 v[120:123], v26 offset:768
    ds_read_b128 v[124:127], v27 offset:768
    s_waitcnt lgkmcnt(0)
    s_barrier
    s_add_u32 m0, s6, 98304
    s_add_u32 s3, s6, 98304
    buffer_load_dwordx4 v8, s[56:59], s3 offen offset:0 nt lds
    buffer_load_dwordx4 v9, s[56:59], s3 offen offset:1024 nt lds
    buffer_load_dwordx4 v10, s[56:59], s3 offen offset:2048 nt lds
    buffer_load_dwordx4 v11, s[56:59], s3 offen offset:3072 nt lds
    ds_read_b128 v[160:163], v12 offset:0
    ds_read_b128 v[164:167], v13 offset:0
    ds_read_b128 v[168:171], v14 offset:0
    ds_read_b128 v[172:175], v15 offset:0
    ds_read_b128 v[176:179], v12 offset:256
    ds_read_b128 v[180:183], v13 offset:256
    ds_read_b128 v[184:187], v14 offset:256
    ds_read_b128 v[188:191], v15 offset:256
    s_waitcnt lgkmcnt(7)
    v_mfma_f32_16x16x32_bf16 v[32:35], v[160:163], v[64:67], 0
    ds_read_b128 v[160:163], v12 offset:512
    s_waitcnt lgkmcnt(7)
    v_mfma_f32_16x16x32_bf16 v[36:39], v[164:167], v[68:71], 0
    ds_read_b128 v[164:167], v13 offset:512
    s_waitcnt lgkmcnt(7)
    v_mfma_f32_16x16x32_bf16 v[32:35], v[168:171], v[72:75], v[32:35]
    ds_read_b128 v[168:171], v14 offset:512
    s_waitcnt lgkmcnt(7)
    v_mfma_f32_16x16x32_bf16 v[36:39], v[172:175], v[76:79], v[36:39]
    ds_read_b128 v[172:175], v15 offset:512
    s_waitcnt lgkmcnt(7)
    v_mfma_f32_16x16x32_bf16 v[32:35], v[176:179], v[80:83], v[32:35]
    ds_read_b128 v[176:179], v12 offset:768
    s_waitcnt lgkmcnt(7)
    v_mfma_f32_16x16x32_bf16 v[36:39], v[180:183], v[84:87], v[36:39]
    ds_read_b128 v[180:183], v13 offset:768
    s_waitcnt lgkmcnt(7)
    v_mfma_f32_16x16x32_bf16 v[32:35], v[184:187], v[88:91], v[32:35]
    ds_read_b128 v[184:187], v14 offset:768
    s_waitcnt lgkmcnt(7)
    v_mfma_f32_16x16x32_bf16 v[36:39], v[188:191], v[92:95], v[36:39]
    ds_read_b128 v[188:191], v15 offset:768
    s_waitcnt lgkmcnt(7)
    v_mfma_f32_16x16x32_bf16 v[32:35], v[160:163], v[96:99], v[32:35]
    s_waitcnt lgkmcnt(6)
    v_mfma_f32_16x16x32_bf16 v[36:39], v[164:167], v[100:103], v[36:39]
    s_waitcnt lgkmcnt(5)
    v_mfma_f32_16x16x32_bf16 v[32:35], v[168:171], v[104:107], v[32:35]
    s_waitcnt lgkmcnt(4)
    v_mfma_f32_16x16x32_bf16 v[36:39], v[172:175], v[108:111], v[36:39]
    s_waitcnt lgkmcnt(3)
    v_mfma_f32_16x16x32_bf16 v[32:35], v[176:179], v[112:115], v[32:35]
    s_waitcnt lgkmcnt(2)
    v_mfma_f32_16x16x32_bf16 v[36:39], v[180:183], v[116:119], v[36:39]
    s_waitcnt lgkmcnt(1)
    v_mfma_f32_16x16x32_bf16 v[32:35], v[184:187], v[120:123], v[32:35]
    s_waitcnt lgkmcnt(0)
    v_mfma_f32_16x16x32_bf16 v[36:39], v[188:191], v[124:127], v[36:39]
    ds_read_b64_tr_b16 v[160:161], v16 offset:0
    ds_read_b64_tr_b16 v[162:163], v17 offset:4096
    ds_read_b64_tr_b16 v[164:165], v18 offset:0
    ds_read_b64_tr_b16 v[166:167], v19 offset:4096
    ds_read_b64_tr_b16 v[168:169], v16 offset:16384
    ds_read_b64_tr_b16 v[170:171], v17 offset:20480
    ds_read_b64_tr_b16 v[172:173], v18 offset:16384
    ds_read_b64_tr_b16 v[174:175], v19 offset:20480
    ds_read_b64_tr_b16 v[176:177], v16 offset:32768
    ds_read_b64_tr_b16 v[178:179], v17 offset:36864
    ds_read_b64_tr_b16 v[180:181], v18 offset:32768
    ds_read_b64_tr_b16 v[182:183], v19 offset:36864
    ds_read_b64_tr_b16 v[184:185], v16 offset:49152
    ds_read_b64_tr_b16 v[186:187], v17 offset:53248
    ds_read_b64_tr_b16 v[188:189], v18 offset:49152
    ds_read_b64_tr_b16 v[190:191], v19 offset:53248
    v_pk_add_f32 v[32:33], v[32:33], v[36:37]
    v_pk_add_f32 v[34:35], v[34:35], v[38:39]
    v_max3_f32 v51, v32, v33, v34
    v_max_f32 v51, v51, v35
    v_mov_b32 v52, v51
    s_nop 1
    v_permlane32_swap_b32 v51, v52
    v_max_f32 v51, v51, v52
    v_mov_b32 v52, v51
    s_nop 1
    v_permlane16_swap_b32 v51, v52
    v_max_f32 v51, v51, v52
    ds_write_b32 v29, v51
    s_waitcnt lgkmcnt(0)
    s_barrier
    ds_read_b128 v[52:55], v20
    ds_read_b128 v[56:59], v21
    s_waitcnt lgkmcnt(1)
    v_max3_f32 v51, v52, v53, v54
    v_max_f32 v48, v51, v55
    v_sub_f32 v32, v32, v48
    v_sub_f32 v33, v33, v48
    v_sub_f32 v34, v34, v48
    v_sub_f32 v35, v35, v48
    v_exp_f32 v32, v32
    v_exp_f32 v33, v33
    v_exp_f32 v34, v34
    v_exp_f32 v35, v35
    v_cvt_pk_bf16_f32 v36, v32, v33
    v_cvt_pk_bf16_f32 v37, v34, v35
    ds_write_b64 v6, v[36:37]
    v_add_f32 v32, v32, v33
    v_add_f32 v34, v34, v35
    v_add_f32 v49, v32, v34
    s_waitcnt lgkmcnt(1)
    v_max3_f32 v51, v56, v57, v58
    v_max_f32 v50, v51, v59
    s_waitcnt lgkmcnt(0)
    s_barrier
    s_add_u32 s3, s6, 131072
    buffer_load_dwordx4 v[192:195], v8, s[56:59], s3 offen offset:0 nt
    buffer_load_dwordx4 v[196:199], v9, s[56:59], s3 offen offset:1024 nt
    buffer_load_dwordx4 v[200:203], v10, s[56:59], s3 offen offset:2048 nt
    buffer_load_dwordx4 v[204:207], v11, s[56:59], s3 offen offset:3072 nt
    ds_read_b128 v[32:35], v7 offset:0
    ds_read_b128 v[36:39], v7 offset:32
    ds_read_b128 v[40:43], v7 offset:64
    ds_read_b128 v[44:47], v7 offset:96
    s_waitcnt lgkmcnt(3)
    v_mfma_f32_32x32x16_bf16 v[128:143], v[160:163], v[32:35], 0
    v_mfma_f32_32x32x16_bf16 v[144:159], v[164:167], v[32:35], 0
    s_waitcnt lgkmcnt(2)
    v_mfma_f32_32x32x16_bf16 v[128:143], v[168:171], v[36:39], v[128:143]
    v_mfma_f32_32x32x16_bf16 v[144:159], v[172:175], v[36:39], v[144:159]
    s_waitcnt lgkmcnt(1)
    v_mfma_f32_32x32x16_bf16 v[128:143], v[176:179], v[40:43], v[128:143]
    v_mfma_f32_32x32x16_bf16 v[144:159], v[180:183], v[40:43], v[144:159]
    s_waitcnt lgkmcnt(0)
    v_mfma_f32_32x32x16_bf16 v[128:143], v[184:187], v[44:47], v[128:143]
    v_mfma_f32_32x32x16_bf16 v[144:159], v[188:191], v[44:47], v[144:159]
    v_xor_b32 v12, 0x10000, v12
    v_xor_b32 v13, 0x10000, v13
    v_xor_b32 v14, 0x10000, v14
    v_xor_b32 v15, 0x10000, v15
    v_xor_b32 v16, 0x10000, v16
    v_xor_b32 v17, 0x10000, v17
    v_xor_b32 v18, 0x10000, v18
    v_xor_b32 v19, 0x10000, v19
    s_waitcnt vmcnt(4)
    s_waitcnt lgkmcnt(0)
    s_barrier
    s_add_u32 s3, s6, 163840
    buffer_load_dwordx4 v[208:211], v8, s[56:59], s3 offen offset:0 nt
    buffer_load_dwordx4 v[212:215], v9, s[56:59], s3 offen offset:1024 nt
    buffer_load_dwordx4 v[216:219], v10, s[56:59], s3 offen offset:2048 nt
    buffer_load_dwordx4 v[220:223], v11, s[56:59], s3 offen offset:3072 nt
    ds_read_b128 v[160:163], v12 offset:0
    ds_read_b128 v[164:167], v13 offset:0
    ds_read_b128 v[168:171], v14 offset:0
    ds_read_b128 v[172:175], v15 offset:0
    ds_read_b128 v[176:179], v12 offset:256
    ds_read_b128 v[180:183], v13 offset:256
    ds_read_b128 v[184:187], v14 offset:256
    ds_read_b128 v[188:191], v15 offset:256
    s_waitcnt lgkmcnt(7)
    v_mfma_f32_16x16x32_bf16 v[32:35], v[160:163], v[64:67], 0
    ds_read_b128 v[160:163], v12 offset:512
    s_waitcnt lgkmcnt(7)
    v_mfma_f32_16x16x32_bf16 v[36:39], v[164:167], v[68:71], 0
    ds_read_b128 v[164:167], v13 offset:512
    s_waitcnt lgkmcnt(7)
    v_mfma_f32_16x16x32_bf16 v[32:35], v[168:171], v[72:75], v[32:35]
    ds_read_b128 v[168:171], v14 offset:512
    s_waitcnt lgkmcnt(7)
    v_mfma_f32_16x16x32_bf16 v[36:39], v[172:175], v[76:79], v[36:39]
    ds_read_b128 v[172:175], v15 offset:512
    s_waitcnt lgkmcnt(7)
    v_mfma_f32_16x16x32_bf16 v[32:35], v[176:179], v[80:83], v[32:35]
    ds_read_b128 v[176:179], v12 offset:768
    s_waitcnt lgkmcnt(7)
    v_mfma_f32_16x16x32_bf16 v[36:39], v[180:183], v[84:87], v[36:39]
    ds_read_b128 v[180:183], v13 offset:768
    s_waitcnt lgkmcnt(7)
    v_mfma_f32_16x16x32_bf16 v[32:35], v[184:187], v[88:91], v[32:35]
    ds_read_b128 v[184:187], v14 offset:768
    s_waitcnt lgkmcnt(7)
    v_mfma_f32_16x16x32_bf16 v[36:39], v[188:191], v[92:95], v[36:39]
    ds_read_b128 v[188:191], v15 offset:768
    s_waitcnt lgkmcnt(7)
    v_mfma_f32_16x16x32_bf16 v[32:35], v[160:163], v[96:99], v[32:35]
    s_waitcnt lgkmcnt(6)
    v_mfma_f32_16x16x32_bf16 v[36:39], v[164:167], v[100:103], v[36:39]
    s_waitcnt lgkmcnt(5)
    v_mfma_f32_16x16x32_bf16 v[32:35], v[168:171], v[104:107], v[32:35]
    s_waitcnt lgkmcnt(4)
    v_mfma_f32_16x16x32_bf16 v[36:39], v[172:175], v[108:111], v[36:39]
    s_waitcnt lgkmcnt(3)
    v_mfma_f32_16x16x32_bf16 v[32:35], v[176:179], v[112:115], v[32:35]
    s_waitcnt lgkmcnt(2)
    v_mfma_f32_16x16x32_bf16 v[36:39], v[180:183], v[116:119], v[36:39]
    s_waitcnt lgkmcnt(1)
    v_mfma_f32_16x16x32_bf16 v[32:35], v[184:187], v[120:123], v[32:35]
    s_waitcnt lgkmcnt(0)
    v_mfma_f32_16x16x32_bf16 v[36:39], v[188:191], v[124:127], v[36:39]
    ds_read_b64_tr_b16 v[160:161], v16 offset:0
    ds_read_b64_tr_b16 v[162:163], v17 offset:4096
    ds_read_b64_tr_b16 v[164:165], v18 offset:0
    ds_read_b64_tr_b16 v[166:167], v19 offset:4096
    ds_read_b64_tr_b16 v[168:169], v16 offset:16384
    ds_read_b64_tr_b16 v[170:171], v17 offset:20480
    ds_read_b64_tr_b16 v[172:173], v18 offset:16384
    ds_read_b64_tr_b16 v[174:175], v19 offset:20480
    ds_read_b64_tr_b16 v[176:177], v16 offset:32768
    ds_read_b64_tr_b16 v[178:179], v17 offset:36864
    ds_read_b64_tr_b16 v[180:181], v18 offset:32768
    ds_read_b64_tr_b16 v[182:183], v19 offset:36864
    ds_read_b64_tr_b16 v[184:185], v16 offset:49152
    ds_read_b64_tr_b16 v[186:187], v17 offset:53248
    ds_read_b64_tr_b16 v[188:189], v18 offset:49152
    ds_read_b64_tr_b16 v[190:191], v19 offset:53248
    v_pk_add_f32 v[32:33], v[32:33], v[36:37]
    v_pk_add_f32 v[34:35], v[34:35], v[38:39]
    v_max3_f32 v51, v32, v33, v34
    v_max_f32 v51, v51, v35
    v_mov_b32 v52, v51
    s_nop 1
    v_permlane32_swap_b32 v51, v52
    v_max_f32 v51, v51, v52
    v_mov_b32 v52, v51
    s_nop 1
    v_permlane16_swap_b32 v51, v52
    v_max_f32 v51, v51, v52
    ds_write_b32 v29, v51
    s_waitcnt lgkmcnt(0)
    s_barrier
    ds_read_b128 v[52:55], v20
    ds_read_b128 v[56:59], v21
    s_waitcnt lgkmcnt(1)
    v_max3_f32 v51, v52, v53, v54
    v_max3_f32 v51, v51, v55, v48
    v_sub_f32 v52, v48, v51
    v_exp_f32 v52, v52
    v_mov_b32 v48, v51
    v_sub_f32 v32, v32, v48
    v_sub_f32 v33, v33, v48
    v_sub_f32 v34, v34, v48
    v_sub_f32 v35, v35, v48
    v_exp_f32 v32, v32
    v_exp_f32 v33, v33
    v_exp_f32 v34, v34
    v_exp_f32 v35, v35
    v_cvt_pk_bf16_f32 v36, v32, v33
    v_cvt_pk_bf16_f32 v37, v34, v35
    ds_write_b64 v6, v[36:37]
    v_add_f32 v32, v32, v33
    v_add_f32 v34, v34, v35
    v_add_f32 v32, v32, v34
    v_fma_f32 v49, v49, v52, v32
    s_waitcnt lgkmcnt(1)
    v_max3_f32 v51, v56, v57, v58
    v_max3_f32 v51, v51, v59, v50
    v_sub_f32 v52, v50, v51
    v_exp_f32 v52, v52
    v_mov_b32 v50, v51
    v_mov_b32 v53, v52
    v_pk_mul_f32 v[128:129], v[128:129], v[52:53]
    v_pk_mul_f32 v[130:131], v[130:131], v[52:53]
    v_pk_mul_f32 v[132:133], v[132:133], v[52:53]
    v_pk_mul_f32 v[134:135], v[134:135], v[52:53]
    v_pk_mul_f32 v[136:137], v[136:137], v[52:53]
    v_pk_mul_f32 v[138:139], v[138:139], v[52:53]
    v_pk_mul_f32 v[140:141], v[140:141], v[52:53]
    v_pk_mul_f32 v[142:143], v[142:143], v[52:53]
    v_pk_mul_f32 v[144:145], v[144:145], v[52:53]
    v_pk_mul_f32 v[146:147], v[146:147], v[52:53]
    v_pk_mul_f32 v[148:149], v[148:149], v[52:53]
    v_pk_mul_f32 v[150:151], v[150:151], v[52:53]
    v_pk_mul_f32 v[152:153], v[152:153], v[52:53]
    v_pk_mul_f32 v[154:155], v[154:155], v[52:53]
    v_pk_mul_f32 v[156:157], v[156:157], v[52:53]
    v_pk_mul_f32 v[158:159], v[158:159], v[52:53]
    s_waitcnt lgkmcnt(0)
    s_barrier
    s_add_u32 s3, s6, 196608
    buffer_load_dwordx4 v[224:227], v8, s[56:59], s3 offen offset:0 nt
    buffer_load_dwordx4 v[228:231], v9, s[56:59], s3 offen offset:1024 nt
    buffer_load_dwordx4 v[232:235], v10, s[56:59], s3 offen offset:2048 nt
    buffer_load_dwordx4 v[236:239], v11, s[56:59], s3 offen offset:3072 nt
    ds_read_b128 v[32:35], v7 offset:0
    ds_read_b128 v[36:39], v7 offset:32
    ds_read_b128 v[40:43], v7 offset:64
    ds_read_b128 v[44:47], v7 offset:96
    s_waitcnt lgkmcnt(3)
    v_mfma_f32_32x32x16_bf16 v[128:143], v[160:163], v[32:35], v[128:143]
    v_mfma_f32_32x32x16_bf16 v[144:159], v[164:167], v[32:35], v[144:159]
    s_waitcnt lgkmcnt(2)
    v_mfma_f32_32x32x16_bf16 v[128:143], v[168:171], v[36:39], v[128:143]
    v_mfma_f32_32x32x16_bf16 v[144:159], v[172:175], v[36:39], v[144:159]
    s_waitcnt lgkmcnt(1)
    v_mfma_f32_32x32x16_bf16 v[128:143], v[176:179], v[40:43], v[128:143]
    v_mfma_f32_32x32x16_bf16 v[144:159], v[180:183], v[40:43], v[144:159]
    s_waitcnt lgkmcnt(0)
    v_mfma_f32_32x32x16_bf16 v[128:143], v[184:187], v[44:47], v[128:143]
    v_mfma_f32_32x32x16_bf16 v[144:159], v[188:191], v[44:47], v[144:159]
    v_xor_b32 v12, 0x10000, v12
    v_xor_b32 v13, 0x10000, v13
    v_xor_b32 v14, 0x10000, v14
    v_xor_b32 v15, 0x10000, v15
    v_xor_b32 v16, 0x10000, v16
    v_xor_b32 v17, 0x10000, v17
    v_xor_b32 v18, 0x10000, v18
    v_xor_b32 v19, 0x10000, v19
    s_waitcnt vmcnt(8)
    ds_write_b128 v62, v[192:195] offset:0
    ds_write_b128 v62, v[196:199] offset:1024
    ds_write_b128 v62, v[200:203] offset:2048
    ds_write_b128 v62, v[204:207] offset:3072
    s_waitcnt vmcnt(4)
    ds_write_b128 v62, v[208:211] offset:32768
    ds_write_b128 v62, v[212:215] offset:33792
    ds_write_b128 v62, v[216:219] offset:34816
    ds_write_b128 v62, v[220:223] offset:35840
    s_waitcnt lgkmcnt(0)
    s_barrier
    s_add_u32 s3, s6, 229376
    buffer_load_dwordx4 v[240:243], v8, s[56:59], s3 offen offset:0 nt
    buffer_load_dwordx4 v[244:247], v9, s[56:59], s3 offen offset:1024 nt
    buffer_load_dwordx4 v[248:251], v10, s[56:59], s3 offen offset:2048 nt
    buffer_load_dwordx4 v[252:255], v11, s[56:59], s3 offen offset:3072 nt
    ds_read_b128 v[160:163], v12 offset:0
    ds_read_b128 v[164:167], v13 offset:0
    ds_read_b128 v[168:171], v14 offset:0
    ds_read_b128 v[172:175], v15 offset:0
    ds_read_b128 v[176:179], v12 offset:256
    ds_read_b128 v[180:183], v13 offset:256
    ds_read_b128 v[184:187], v14 offset:256
    ds_read_b128 v[188:191], v15 offset:256
    ds_read_b128 v[192:195], v12 offset:512
    ds_read_b128 v[196:199], v13 offset:512
    ds_read_b128 v[200:203], v14 offset:512
    ds_read_b128 v[204:207], v15 offset:512
    ds_read_b128 v[208:211], v12 offset:768
    ds_read_b128 v[212:215], v13 offset:768
    ds_read_b128 v[216:219], v14 offset:768
    ds_read_b128 v[220:223], v15 offset:768
    s_waitcnt lgkmcnt(15)
    v_mfma_f32_16x16x32_bf16 v[32:35], v[160:163], v[64:67], 0
    s_waitcnt lgkmcnt(14)
    v_mfma_f32_16x16x32_bf16 v[36:39], v[164:167], v[68:71], 0
    s_waitcnt lgkmcnt(13)
    v_mfma_f32_16x16x32_bf16 v[32:35], v[168:171], v[72:75], v[32:35]
    s_waitcnt lgkmcnt(12)
    v_mfma_f32_16x16x32_bf16 v[36:39], v[172:175], v[76:79], v[36:39]
    s_waitcnt lgkmcnt(11)
    v_mfma_f32_16x16x32_bf16 v[32:35], v[176:179], v[80:83], v[32:35]
    s_waitcnt lgkmcnt(10)
    v_mfma_f32_16x16x32_bf16 v[36:39], v[180:183], v[84:87], v[36:39]
    s_waitcnt lgkmcnt(9)
    v_mfma_f32_16x16x32_bf16 v[32:35], v[184:187], v[88:91], v[32:35]
    s_waitcnt lgkmcnt(8)
    v_mfma_f32_16x16x32_bf16 v[36:39], v[188:191], v[92:95], v[36:39]
    s_waitcnt lgkmcnt(7)
    v_mfma_f32_16x16x32_bf16 v[32:35], v[192:195], v[96:99], v[32:35]
    s_waitcnt lgkmcnt(6)
    v_mfma_f32_16x16x32_bf16 v[36:39], v[196:199], v[100:103], v[36:39]
    s_waitcnt lgkmcnt(5)
    v_mfma_f32_16x16x32_bf16 v[32:35], v[200:203], v[104:107], v[32:35]
    s_waitcnt lgkmcnt(4)
    v_mfma_f32_16x16x32_bf16 v[36:39], v[204:207], v[108:111], v[36:39]
    s_waitcnt lgkmcnt(3)
    v_mfma_f32_16x16x32_bf16 v[32:35], v[208:211], v[112:115], v[32:35]
    s_waitcnt lgkmcnt(2)
    v_mfma_f32_16x16x32_bf16 v[36:39], v[212:215], v[116:119], v[36:39]
    s_waitcnt lgkmcnt(1)
    v_mfma_f32_16x16x32_bf16 v[32:35], v[216:219], v[120:123], v[32:35]
    s_waitcnt lgkmcnt(0)
    v_mfma_f32_16x16x32_bf16 v[36:39], v[220:223], v[124:127], v[36:39]
    ds_read_b64_tr_b16 v[160:161], v16 offset:0
    ds_read_b64_tr_b16 v[162:163], v17 offset:4096
    ds_read_b64_tr_b16 v[164:165], v18 offset:0
    ds_read_b64_tr_b16 v[166:167], v19 offset:4096
    ds_read_b64_tr_b16 v[168:169], v16 offset:16384
    ds_read_b64_tr_b16 v[170:171], v17 offset:20480
    ds_read_b64_tr_b16 v[172:173], v18 offset:16384
    ds_read_b64_tr_b16 v[174:175], v19 offset:20480
    ds_read_b64_tr_b16 v[176:177], v16 offset:32768
    ds_read_b64_tr_b16 v[178:179], v17 offset:36864
    ds_read_b64_tr_b16 v[180:181], v18 offset:32768
    ds_read_b64_tr_b16 v[182:183], v19 offset:36864
    ds_read_b64_tr_b16 v[184:185], v16 offset:49152
    ds_read_b64_tr_b16 v[186:187], v17 offset:53248
    ds_read_b64_tr_b16 v[188:189], v18 offset:49152
    ds_read_b64_tr_b16 v[190:191], v19 offset:53248
    v_pk_add_f32 v[32:33], v[32:33], v[36:37]
    v_pk_add_f32 v[34:35], v[34:35], v[38:39]
    v_max3_f32 v51, v32, v33, v34
    v_max_f32 v51, v51, v35
    v_mov_b32 v52, v51
    s_nop 1
    v_permlane32_swap_b32 v51, v52
    v_max_f32 v51, v51, v52
    v_mov_b32 v52, v51
    s_nop 1
    v_permlane16_swap_b32 v51, v52
    v_max_f32 v51, v51, v52
    ds_write_b32 v29, v51
    s_waitcnt lgkmcnt(0)
    s_barrier
    ds_read_b128 v[52:55], v20
    ds_read_b128 v[56:59], v21
    s_waitcnt lgkmcnt(1)
    v_max3_f32 v51, v52, v53, v54
    v_max3_f32 v51, v51, v55, v48
    v_sub_f32 v52, v48, v51
    v_exp_f32 v52, v52
    v_mov_b32 v48, v51
    v_sub_f32 v32, v32, v48
    v_sub_f32 v33, v33, v48
    v_sub_f32 v34, v34, v48
    v_sub_f32 v35, v35, v48
    v_exp_f32 v32, v32
    v_exp_f32 v33, v33
    v_exp_f32 v34, v34
    v_exp_f32 v35, v35
    v_cvt_pk_bf16_f32 v36, v32, v33
    v_cvt_pk_bf16_f32 v37, v34, v35
    ds_write_b64 v6, v[36:37]
    v_add_f32 v32, v32, v33
    v_add_f32 v34, v34, v35
    v_add_f32 v32, v32, v34
    v_fma_f32 v49, v49, v52, v32
    s_waitcnt lgkmcnt(1)
    v_max3_f32 v51, v56, v57, v58
    v_max3_f32 v51, v51, v59, v50
    v_sub_f32 v52, v50, v51
    v_exp_f32 v52, v52
    v_mov_b32 v50, v51
    v_mov_b32 v53, v52
    v_pk_mul_f32 v[128:129], v[128:129], v[52:53]
    v_pk_mul_f32 v[130:131], v[130:131], v[52:53]
    v_pk_mul_f32 v[132:133], v[132:133], v[52:53]
    v_pk_mul_f32 v[134:135], v[134:135], v[52:53]
    v_pk_mul_f32 v[136:137], v[136:137], v[52:53]
    v_pk_mul_f32 v[138:139], v[138:139], v[52:53]
    v_pk_mul_f32 v[140:141], v[140:141], v[52:53]
    v_pk_mul_f32 v[142:143], v[142:143], v[52:53]
    v_pk_mul_f32 v[144:145], v[144:145], v[52:53]
    v_pk_mul_f32 v[146:147], v[146:147], v[52:53]
    v_pk_mul_f32 v[148:149], v[148:149], v[52:53]
    v_pk_mul_f32 v[150:151], v[150:151], v[52:53]
    v_pk_mul_f32 v[152:153], v[152:153], v[52:53]
    v_pk_mul_f32 v[154:155], v[154:155], v[52:53]
    v_pk_mul_f32 v[156:157], v[156:157], v[52:53]
    v_pk_mul_f32 v[158:159], v[158:159], v[52:53]
    s_waitcnt lgkmcnt(0)
    s_barrier
    ds_read_b128 v[32:35], v7 offset:0
    ds_read_b128 v[36:39], v7 offset:32
    ds_read_b128 v[40:43], v7 offset:64
    ds_read_b128 v[44:47], v7 offset:96
    s_waitcnt lgkmcnt(3)
    v_mfma_f32_32x32x16_bf16 v[128:143], v[160:163], v[32:35], v[128:143]
    v_mfma_f32_32x32x16_bf16 v[144:159], v[164:167], v[32:35], v[144:159]
    s_waitcnt lgkmcnt(2)
    v_mfma_f32_32x32x16_bf16 v[128:143], v[168:171], v[36:39], v[128:143]
    v_mfma_f32_32x32x16_bf16 v[144:159], v[172:175], v[36:39], v[144:159]
    s_waitcnt lgkmcnt(1)
    v_mfma_f32_32x32x16_bf16 v[128:143], v[176:179], v[40:43], v[128:143]
    v_mfma_f32_32x32x16_bf16 v[144:159], v[180:183], v[40:43], v[144:159]
    s_waitcnt lgkmcnt(0)
    v_mfma_f32_32x32x16_bf16 v[128:143], v[184:187], v[44:47], v[128:143]
    v_mfma_f32_32x32x16_bf16 v[144:159], v[188:191], v[44:47], v[144:159]
    v_xor_b32 v12, 0x10000, v12
    v_xor_b32 v13, 0x10000, v13
    v_xor_b32 v14, 0x10000, v14
    v_xor_b32 v15, 0x10000, v15
    v_xor_b32 v16, 0x10000, v16
    v_xor_b32 v17, 0x10000, v17
    v_xor_b32 v18, 0x10000, v18
    v_xor_b32 v19, 0x10000, v19
    s_waitcnt vmcnt(4)
    ds_write_b128 v63, v[224:227] offset:0
    ds_write_b128 v63, v[228:231] offset:1024
    ds_write_b128 v63, v[232:235] offset:2048
    ds_write_b128 v63, v[236:239] offset:3072
    s_waitcnt vmcnt(0)
    ds_write_b128 v63, v[240:243] offset:32768
    ds_write_b128 v63, v[244:247] offset:33792
    ds_write_b128 v63, v[248:251] offset:34816
    ds_write_b128 v63, v[252:255] offset:35840
    s_waitcnt lgkmcnt(0)
    s_barrier
    ds_read_b128 v[160:163], v12 offset:0
    ds_read_b128 v[164:167], v13 offset:0
    ds_read_b128 v[168:171], v14 offset:0
    ds_read_b128 v[172:175], v15 offset:0
    ds_read_b128 v[176:179], v12 offset:256
    ds_read_b128 v[180:183], v13 offset:256
    ds_read_b128 v[184:187], v14 offset:256
    ds_read_b128 v[188:191], v15 offset:256
    ds_read_b128 v[192:195], v12 offset:512
    ds_read_b128 v[196:199], v13 offset:512
    ds_read_b128 v[200:203], v14 offset:512
    ds_read_b128 v[204:207], v15 offset:512
    ds_read_b128 v[208:211], v12 offset:768
    ds_read_b128 v[212:215], v13 offset:768
    ds_read_b128 v[216:219], v14 offset:768
    ds_read_b128 v[220:223], v15 offset:768
    s_waitcnt lgkmcnt(15)
    v_mfma_f32_16x16x32_bf16 v[32:35], v[160:163], v[64:67], 0
    s_waitcnt lgkmcnt(14)
    v_mfma_f32_16x16x32_bf16 v[36:39], v[164:167], v[68:71], 0
    s_waitcnt lgkmcnt(13)
    v_mfma_f32_16x16x32_bf16 v[32:35], v[168:171], v[72:75], v[32:35]
    s_waitcnt lgkmcnt(12)
    v_mfma_f32_16x16x32_bf16 v[36:39], v[172:175], v[76:79], v[36:39]
    s_waitcnt lgkmcnt(11)
    v_mfma_f32_16x16x32_bf16 v[32:35], v[176:179], v[80:83], v[32:35]
    s_waitcnt lgkmcnt(10)
    v_mfma_f32_16x16x32_bf16 v[36:39], v[180:183], v[84:87], v[36:39]
    s_waitcnt lgkmcnt(9)
    v_mfma_f32_16x16x32_bf16 v[32:35], v[184:187], v[88:91], v[32:35]
    s_waitcnt lgkmcnt(8)
    v_mfma_f32_16x16x32_bf16 v[36:39], v[188:191], v[92:95], v[36:39]
    s_waitcnt lgkmcnt(7)
    v_mfma_f32_16x16x32_bf16 v[32:35], v[192:195], v[96:99], v[32:35]
    s_waitcnt lgkmcnt(6)
    v_mfma_f32_16x16x32_bf16 v[36:39], v[196:199], v[100:103], v[36:39]
    s_waitcnt lgkmcnt(5)
    v_mfma_f32_16x16x32_bf16 v[32:35], v[200:203], v[104:107], v[32:35]
    s_waitcnt lgkmcnt(4)
    v_mfma_f32_16x16x32_bf16 v[36:39], v[204:207], v[108:111], v[36:39]
    s_waitcnt lgkmcnt(3)
    v_mfma_f32_16x16x32_bf16 v[32:35], v[208:211], v[112:115], v[32:35]
    s_waitcnt lgkmcnt(2)
    v_mfma_f32_16x16x32_bf16 v[36:39], v[212:215], v[116:119], v[36:39]
    s_waitcnt lgkmcnt(1)
    v_mfma_f32_16x16x32_bf16 v[32:35], v[216:219], v[120:123], v[32:35]
    s_waitcnt lgkmcnt(0)
    v_mfma_f32_16x16x32_bf16 v[36:39], v[220:223], v[124:127], v[36:39]
    ds_read_b64_tr_b16 v[224:225], v16 offset:0
    ds_read_b64_tr_b16 v[226:227], v17 offset:4096
    ds_read_b64_tr_b16 v[228:229], v18 offset:0
    ds_read_b64_tr_b16 v[230:231], v19 offset:4096
    ds_read_b64_tr_b16 v[232:233], v16 offset:16384
    ds_read_b64_tr_b16 v[234:235], v17 offset:20480
    ds_read_b64_tr_b16 v[236:237], v18 offset:16384
    ds_read_b64_tr_b16 v[238:239], v19 offset:20480
    ds_read_b64_tr_b16 v[240:241], v16 offset:32768
    ds_read_b64_tr_b16 v[242:243], v17 offset:36864
    ds_read_b64_tr_b16 v[244:245], v18 offset:32768
    ds_read_b64_tr_b16 v[246:247], v19 offset:36864
    ds_read_b64_tr_b16 v[248:249], v16 offset:49152
    ds_read_b64_tr_b16 v[250:251], v17 offset:53248
    ds_read_b64_tr_b16 v[252:253], v18 offset:49152
    ds_read_b64_tr_b16 v[254:255], v19 offset:53248
    v_pk_add_f32 v[32:33], v[32:33], v[36:37]
    v_pk_add_f32 v[34:35], v[34:35], v[38:39]
    v_max3_f32 v51, v32, v33, v34
    v_max_f32 v51, v51, v35
    v_mov_b32 v52, v51
    s_nop 1
    v_permlane32_swap_b32 v51, v52
    v_max_f32 v51, v51, v52
    v_mov_b32 v52, v51
    s_nop 1
    v_permlane16_swap_b32 v51, v52
    v_max_f32 v51, v51, v52
    ds_write_b32 v29, v51
    s_waitcnt lgkmcnt(0)
    s_barrier
    ds_read_b128 v[52:55], v20
    ds_read_b128 v[56:59], v21
    s_waitcnt lgkmcnt(1)
    v_max3_f32 v51, v52, v53, v54
    v_max3_f32 v51, v51, v55, v48
    v_sub_f32 v52, v48, v51
    v_exp_f32 v52, v52
    v_mov_b32 v48, v51
    v_sub_f32 v32, v32, v48
    v_sub_f32 v33, v33, v48
    v_sub_f32 v34, v34, v48
    v_sub_f32 v35, v35, v48
    v_exp_f32 v32, v32
    v_exp_f32 v33, v33
    v_exp_f32 v34, v34
    v_exp_f32 v35, v35
    v_cvt_pk_bf16_f32 v36, v32, v33
    v_cvt_pk_bf16_f32 v37, v34, v35
    ds_write_b64 v6, v[36:37]
    v_add_f32 v32, v32, v33
    v_add_f32 v34, v34, v35
    v_add_f32 v32, v32, v34
    v_fma_f32 v49, v49, v52, v32
    v_mov_b32 v52, v49
    s_nop 1
    v_permlane32_swap_b32 v49, v52
    v_add_f32 v49, v49, v52
    v_mov_b32 v52, v49
    s_nop 1
    v_permlane16_swap_b32 v49, v52
    v_add_f32 v49, v49, v52
    ds_write_b32 v29, v49 offset:512
    s_waitcnt lgkmcnt(2)
    v_max3_f32 v51, v56, v57, v58
    v_max3_f32 v51, v51, v59, v50
    v_sub_f32 v52, v50, v51
    v_exp_f32 v52, v52
    v_mov_b32 v50, v51
    v_mov_b32 v53, v52
    v_pk_mul_f32 v[128:129], v[128:129], v[52:53]
    v_pk_mul_f32 v[130:131], v[130:131], v[52:53]
    v_pk_mul_f32 v[132:133], v[132:133], v[52:53]
    v_pk_mul_f32 v[134:135], v[134:135], v[52:53]
    v_pk_mul_f32 v[136:137], v[136:137], v[52:53]
    v_pk_mul_f32 v[138:139], v[138:139], v[52:53]
    v_pk_mul_f32 v[140:141], v[140:141], v[52:53]
    v_pk_mul_f32 v[142:143], v[142:143], v[52:53]
    v_pk_mul_f32 v[144:145], v[144:145], v[52:53]
    v_pk_mul_f32 v[146:147], v[146:147], v[52:53]
    v_pk_mul_f32 v[148:149], v[148:149], v[52:53]
    v_pk_mul_f32 v[150:151], v[150:151], v[52:53]
    v_pk_mul_f32 v[152:153], v[152:153], v[52:53]
    v_pk_mul_f32 v[154:155], v[154:155], v[52:53]
    v_pk_mul_f32 v[156:157], v[156:157], v[52:53]
    v_pk_mul_f32 v[158:159], v[158:159], v[52:53]
    s_waitcnt lgkmcnt(0)
    s_barrier
    ds_read_b128 v[32:35], v7 offset:0
    ds_read_b128 v[36:39], v7 offset:32
    ds_read_b128 v[40:43], v7 offset:64
    ds_read_b128 v[44:47], v7 offset:96
    ds_read_b128 v[56:59], v21 offset:512
    s_waitcnt lgkmcnt(4)
    v_mfma_f32_32x32x16_bf16 v[128:143], v[224:227], v[32:35], v[128:143]
    v_mfma_f32_32x32x16_bf16 v[144:159], v[228:231], v[32:35], v[144:159]
    s_waitcnt lgkmcnt(3)
    v_mfma_f32_32x32x16_bf16 v[128:143], v[232:235], v[36:39], v[128:143]
    v_mfma_f32_32x32x16_bf16 v[144:159], v[236:239], v[36:39], v[144:159]
    s_waitcnt lgkmcnt(2)
    v_mfma_f32_32x32x16_bf16 v[128:143], v[240:243], v[40:43], v[128:143]
    v_mfma_f32_32x32x16_bf16 v[144:159], v[244:247], v[40:43], v[144:159]
    s_waitcnt lgkmcnt(1)
    v_mfma_f32_32x32x16_bf16 v[128:143], v[248:251], v[44:47], v[128:143]
    v_mfma_f32_32x32x16_bf16 v[144:159], v[252:255], v[44:47], v[144:159]
    s_waitcnt lgkmcnt(0)
    v_add_f32 v56, v56, v57
    v_add_f32 v58, v58, v59
    v_add_f32 v56, v56, v58
    v_rcp_f32 v52, v56
    v_log_f32 v57, v56
    v_and_b32 v22, 31, v0
    v_lshlrev_b32 v23, 10, v22
    s_lshl_b32 s3, s7, 3
    s_add_u32 s3, s3, 7602176
    v_add_f32 v56, v57, v50
    v_mov_b32 v53, v52
    v_mov_b32 v57, v31
    s_cmp_lg_u32 s34, 0
    s_cbranch_scc1 SKIP_5
    s_mov_b64 exec, 0xffffffff
    buffer_store_dwordx2 v[56:57], v23, s[40:43], s3 offen sc1
    s_mov_b64 exec, -1
SKIP_5:
    s_mul_i32 s3, s34, 4608
    v_mul_u32_u24 v22, 144, v22
    v_lshrrev_b32 v23, 5, v0
    v_lshl_add_u32 v22, v23, 3, v22
    v_add_u32 v22, s3, v22
    v_lshrrev_b32 v24, 3, v0
    v_mul_u32_u24 v23, 144, v24
    v_lshl_add_u32 v23, v5, 4, v23
    v_add_u32 v23, s3, v23
    v_lshlrev_b32 v24, 17, v24
    v_lshl_add_u32 v24, v5, 4, v24
    s_lshr_b32 s3, s34, 1
    s_lshl_b32 s3, s3, 15
    s_lshl_b32 s13, s7, 8
    s_add_u32 s3, s3, s13
    s_and_b32 s13, s34, 1
    s_lshl_b32 s13, s13, 7
    s_add_u32 s3, s3, s13
    s_add_u32 s3, s3, 3145728
    v_pk_mul_f32 v[128:129], v[128:129], v[52:53]
    v_pk_mul_f32 v[130:131], v[130:131], v[52:53]
    v_perm_b32 v128, v129, v128, s99
    v_bfi_b32 v128, s100, v30, v128
    v_perm_b32 v129, v131, v130, s99
    v_bfi_b32 v129, s100, v30, v129
    ds_write_b64 v22, v[128:129] offset:0
    v_pk_mul_f32 v[132:133], v[132:133], v[52:53]
    v_pk_mul_f32 v[134:135], v[134:135], v[52:53]
    v_perm_b32 v132, v133, v132, s99
    v_bfi_b32 v132, s100, v30, v132
    v_perm_b32 v133, v135, v134, s99
    v_bfi_b32 v133, s100, v30, v133
    ds_write_b64 v22, v[132:133] offset:16
    v_pk_mul_f32 v[136:137], v[136:137], v[52:53]
    v_pk_mul_f32 v[138:139], v[138:139], v[52:53]
    v_perm_b32 v136, v137, v136, s99
    v_bfi_b32 v136, s100, v30, v136
    v_perm_b32 v137, v139, v138, s99
    v_bfi_b32 v137, s100, v30, v137
    ds_write_b64 v22, v[136:137] offset:32
    v_pk_mul_f32 v[140:141], v[140:141], v[52:53]
    v_pk_mul_f32 v[142:143], v[142:143], v[52:53]
    v_perm_b32 v140, v141, v140, s99
    v_bfi_b32 v140, s100, v30, v140
    v_perm_b32 v141, v143, v142, s99
    v_bfi_b32 v141, s100, v30, v141
    ds_write_b64 v22, v[140:141] offset:48
    v_pk_mul_f32 v[144:145], v[144:145], v[52:53]
    v_pk_mul_f32 v[146:147], v[146:147], v[52:53]
    v_perm_b32 v144, v145, v144, s99
    v_bfi_b32 v144, s100, v30, v144
    v_perm_b32 v145, v147, v146, s99
    v_bfi_b32 v145, s100, v30, v145
    ds_write_b64 v22, v[144:145] offset:64
    v_pk_mul_f32 v[148:149], v[148:149], v[52:53]
    v_pk_mul_f32 v[150:151], v[150:151], v[52:53]
    v_perm_b32 v148, v149, v148, s99
    v_bfi_b32 v148, s100, v30, v148
    v_perm_b32 v149, v151, v150, s99
    v_bfi_b32 v149, s100, v30, v149
    ds_write_b64 v22, v[148:149] offset:80
    v_pk_mul_f32 v[152:153], v[152:153], v[52:53]
    v_pk_mul_f32 v[154:155], v[154:155], v[52:53]
    v_perm_b32 v152, v153, v152, s99
    v_bfi_b32 v152, s100, v30, v152
    v_perm_b32 v153, v155, v154, s99
    v_bfi_b32 v153, s100, v30, v153
    ds_write_b64 v22, v[152:153] offset:96
    v_pk_mul_f32 v[156:157], v[156:157], v[52:53]
    v_pk_mul_f32 v[158:159], v[158:159], v[52:53]
    v_perm_b32 v156, v157, v156, s99
    v_bfi_b32 v156, s100, v30, v156
    v_perm_b32 v157, v159, v158, s99
    v_bfi_b32 v157, s100, v30, v157
    ds_write_b64 v22, v[156:157] offset:112
    s_waitcnt lgkmcnt(0)
    ds_read_b128 v[160:163], v23 offset:0
    ds_read_b128 v[164:167], v23 offset:1152
    ds_read_b128 v[168:171], v23 offset:2304
    ds_read_b128 v[172:175], v23 offset:3456
    s_waitcnt lgkmcnt(3)
    buffer_store_dwordx4 v[160:163], v24, s[40:43], s3 offen sc1
    s_add_u32 s3, s3, 0x100000
    s_waitcnt lgkmcnt(2)
    buffer_store_dwordx4 v[164:167], v24, s[40:43], s3 offen sc1
    s_add_u32 s3, s3, 0x100000
    s_waitcnt lgkmcnt(1)
    buffer_store_dwordx4 v[168:171], v24, s[40:43], s3 offen sc1
    s_add_u32 s3, s3, 0x100000
    s_waitcnt lgkmcnt(0)
    buffer_store_dwordx4 v[172:175], v24, s[40:43], s3 offen sc1
    s_lshl_b32 s13, s39, 14
    s_lshl_b32 s3, s34, 11
    s_add_u32 s13, s13, s3
    s_lshr_b32 s15, s13, 3
    s_add_u32 s15, s15, 7340032
    s_add_u32 s13, s13, 1048576
    v_lshlrev_b32 v22, 4, v0
    v_mov_b32 v26, 0
    buffer_load_dword v32, v26, s[40:43], s15 offen sc1
    s_waitcnt vmcnt(0)
CHK_6:
    v_bitop3_b32 v48, v32, v32, v31 bitop3:0x7e
    v_and_b32 v48, s101, v48
    v_cmp_ne_u32 vcc, 0, v48
    s_nop 0
    s_cbranch_vccz DONE_7
    s_cmp_eq_u32 s77, 0
    s_cbranch_scc1 DONE_7
    s_sub_u32 s77, s77, 1
    buffer_load_dword v32, v26, s[40:43], s15 offen sc1
    s_waitcnt vmcnt(0)
    s_branch CHK_6
DONE_7:
    buffer_load_dwordx4 v[32:35], v22, s[40:43], s13 offen offset:0 sc1
    buffer_load_dwordx4 v[36:39], v22, s[40:43], s13 offen offset:1024 sc1
    s_lshl_b32 s3, s34, 7
    s_add_u32 s3, s3, 136704
    v_lshl_add_u32 v23, v5, 4, s3
    v_and_b32 v24, 31, v0
    v_lshlrev_b32 v24, 2, v24
    v_add_u32 v24, 136704, v24
    v_lshlrev_b32 v25, 1, v0
    s_lshl_b32 s14, s39, 6
    s_waitcnt vmcnt(0)
CHK_8:
    v_bitop3_b32 v48, v32, v33, v31 bitop3:0x7e
    v_bitop3_b32 v49, v34, v35, v31 bitop3:0x7e
    v_bitop3_b32 v50, v36, v37, v31 bitop3:0x7e
    v_or3_b32 v48, v48, v49, v50
    v_bitop3_b32 v49, v38, v39, v31 bitop3:0x7e
    v_or_b32 v48, v48, v49
    v_and_b32 v48, s101, v48
    v_cmp_ne_u32 vcc, 0, v48
    s_nop 0
    s_cbranch_vccz DONE_9
    s_cmp_eq_u32 s77, 0
    s_cbranch_scc1 DONE_9
    s_sub_u32 s77, s77, 1
    buffer_load_dwordx4 v[32:35], v22, s[40:43], s13 offen offset:0 sc1
    buffer_load_dwordx4 v[36:39], v22, s[40:43], s13 offen offset:1024 sc1
    s_waitcnt vmcnt(0)
    s_branch CHK_8
DONE_9:
    v_pk_add_f32 v[32:33], v[32:33], v[36:37]
    v_pk_add_f32 v[34:35], v[34:35], v[38:39]
    s_nop 0
    v_add_f32_dpp v32, v32, v32 row_ror:8 row_mask:0xf bank_mask:0xf
    v_add_f32_dpp v33, v33, v33 row_ror:8 row_mask:0xf bank_mask:0xf
    v_add_f32_dpp v34, v34, v34 row_ror:8 row_mask:0xf bank_mask:0xf
    v_add_f32_dpp v35, v35, v35 row_ror:8 row_mask:0xf bank_mask:0xf
    v_mov_b32 v36, v32
    s_nop 1
    v_permlane32_swap_b32 v32, v36
    v_add_f32 v32, v32, v36
    v_mov_b32 v36, v32
    s_nop 1
    v_permlane16_swap_b32 v32, v36
    v_add_f32 v32, v32, v36
    v_mov_b32 v37, v33
    s_nop 1
    v_permlane32_swap_b32 v33, v37
    v_add_f32 v33, v33, v37
    v_mov_b32 v37, v33
    s_nop 1
    v_permlane16_swap_b32 v33, v37
    v_add_f32 v33, v33, v37
    v_mov_b32 v38, v34
    s_nop 1
    v_permlane32_swap_b32 v34, v38
    v_add_f32 v34, v34, v38
    v_mov_b32 v38, v34
    s_nop 1
    v_permlane16_swap_b32 v34, v38
    v_add_f32 v34, v34, v38
    v_mov_b32 v39, v35
    s_nop 1
    v_permlane32_swap_b32 v35, v39
    v_add_f32 v35, v35, v39
    v_mov_b32 v39, v35
    s_nop 1
    v_permlane16_swap_b32 v35, v39
    v_add_f32 v35, v35, v39
    ds_write_b128 v23, v[32:35]
    s_waitcnt lgkmcnt(0)
    s_barrier
    s_cmp_lg_u32 s34, 0
    s_cbranch_scc1 SKIP_10
    ds_read_b32 v32, v24 offset:0
    ds_read_b32 v33, v24 offset:128
    ds_read_b32 v34, v24 offset:256
    ds_read_b32 v35, v24 offset:384
    ds_read_b32 v36, v24 offset:512
    ds_read_b32 v37, v24 offset:640
    ds_read_b32 v38, v24 offset:768
    ds_read_b32 v39, v24 offset:896
    s_waitcnt lgkmcnt(0)
    v_add_f32 v32, v32, v33
    v_add_f32 v34, v34, v35
    v_add_f32 v36, v36, v37
    v_add_f32 v38, v38, v39
    v_add_f32 v32, v32, v34
    v_add_f32 v36, v36, v38
    v_add_f32 v32, v32, v36
    v_cvt_pk_bf16_f32 v32, v32, v32
    s_mov_b64 exec, 0xffffffff
    buffer_store_short v32, v25, s[60:63], s14 offen
    s_cmp_lg_u32 s39, 0
    s_cbranch_scc1 SKIP_10
    s_mov_b64 exec, 1
    v_mov_b32 v22, 0
    v_mov_b32 v23, s76
    buffer_store_dword v23, v22, s[40:43], 0 offen sc1
SKIP_10:
    s_mov_b64 exec, -1
    s_endpgm
L_B:
    s_lshl_b32 s4, s37, 2
    s_add_u32 s4, s4, s38
    s_lshl_b32 s3, s4, 6
    s_add_u32 s48, s22, s3
    s_addc_u32 s49, s23, 0
    s_mov_b32 s50, 4186176
    s_mov_b32 s51, 0x20000
    s_lshl_b32 s7, s34, 14
    v_lshrrev_b32 v28, 5, v0
    v_lshlrev_b32 v28, 1, v28
    v_xor_b32 v28, v28, v4
    v_lshlrev_b32 v28, 4, v28
    v_lshrrev_b32 v29, 2, v0
    v_lshl_add_u32 v12, v29, 13, v28
    s_lshl_b32 s3, s34, 19
    s_add_u32 m0, s7, 12288
    s_nop 0
    buffer_load_dwordx4 v12, s[48:51], s3 offen nt lds
    s_add_u32 m0, m0, 1024
    s_add_u32 s3, s3, 0x20000
    buffer_load_dwordx4 v12, s[48:51], s3 offen nt lds
    s_add_u32 m0, m0, 1024
    s_add_u32 s3, s3, 0x20000
    buffer_load_dwordx4 v12, s[48:51], s3 offen nt lds
    s_add_u32 m0, m0, 1024
    s_add_u32 s3, s3, 0x20000
    buffer_load_dwordx4 v12, s[48:51], s3 offen nt lds
    s_mov_b32 s72, s26
    s_mov_b32 s73, s27
    s_mov_b32 s74, 1024
    s_mov_b32 s75, 0x20000
    v_lshlrev_b32 v28, 10, v5
    v_lshl_add_u32 v28, v1, 4, v28
    s_lshl_b32 s3, s34, 7
    v_lshlrev_b32 v29, 4, v0
    s_lshl_b32 s11, s34, 10
    buffer_load_dwordx4 v[32:35], v28, s[44:47], s3 offen
    buffer_load_dwordx4 v[36:39], v28, s[44:47], s3 offen offset:64
    buffer_load_dwordx4 v[40:43], v29, s[44:47], s11 offen
    buffer_load_dwordx4 v[44:47], v29, s[72:75], 0 offen
    s_lshl_b32 s3, s35, 23
    s_lshr_b32 s5, s36, 1
    s_lshl_b32 s6, s5, 20
    s_add_u32 s3, s3, s6
    s_and_b32 s6, s36, 1
    s_lshl_b32 s8, s6, 17
    s_add_u32 s3, s3, s8
    s_add_u32 s3, s3, 786432
    s_add_u32 s52, s18, s3
    s_addc_u32 s53, s19, 0
    s_mov_b32 s54, 131072
    s_mov_b32 s55, 0x20000
    s_add_u32 s56, s20, s3
    s_addc_u32 s57, s21, 0
    s_mov_b32 s58, 131072
    s_mov_b32 s59, 0x20000
    s_lshl_b32 s3, s37, 8
    s_lshl_b32 s8, s38, 20
    s_add_u32 s3, s3, s8
    s_add_u32 s60, s12, s3
    s_addc_u32 s61, s13, 0
    s_mov_b32 s62, 1040640
    s_mov_b32 s63, 0x20000
    s_lshl_b32 s3, s37, 17
    s_add_u32 s64, s14, s3
    s_addc_u32 s65, s15, 0
    s_mov_b32 s66, 131072
    s_mov_b32 s67, 0x20000
    s_lshl_b32 s3, s4, 15
    s_add_u32 s68, s24, s3
    s_addc_u32 s69, s25, 0
    s_mov_b32 s70, 32768
    s_mov_b32 s71, 0x20000
    s_mov_b32 s8, 4096
    s_mov_b32 s9, 8192
    s_mov_b32 s10, 12288
    v_bfe_u32 v13, v0, 3, 1
    v_lshlrev_b32 v13, 6, v13
    v_lshl_add_u32 v13, v5, 8, v13
    v_lshl_add_u32 v13, v1, 4, v13
    v_add_u32 v13, s7, v13
    v_lshlrev_b32 v6, 10, v1
    v_lshl_add_u32 v6, v2, 4, v6
    v_add_u32 v6, s7, v6
    s_barrier
    buffer_load_dwordx4 v[64:67], v13, s[52:55], 0 offen offset:0 nt
    buffer_load_dwordx4 v[68:71], v13, s[52:55], 0 offen offset:128 nt
    buffer_load_dwordx4 v[72:75], v13, s[52:55], 0 offen offset:2048 nt
    buffer_load_dwordx4 v[76:79], v13, s[52:55], 0 offen offset:2176 nt
    s_barrier
    buffer_load_dwordx4 v[80:83], v13, s[52:55], s8 offen offset:0 nt
    buffer_load_dwordx4 v[84:87], v13, s[52:55], s8 offen offset:128 nt
    buffer_load_dwordx4 v[88:91], v13, s[52:55], s8 offen offset:2048 nt
    buffer_load_dwordx4 v[92:95], v13, s[52:55], s8 offen offset:2176 nt
    v_lshlrev_b32 v28, 1, v1
    v_xor_b32 v28, v28, v2
    v_lshlrev_b32 v28, 4, v28
    v_lshl_add_u32 v10, v1, 13, v28
    v_xor_b32 v11, 128, v10
    v_and_b32 v28, 1, v1
    v_lshlrev_b32 v28, 1, v28
    v_xor_b32 v28, v28, v5
    v_lshlrev_b32 v28, 4, v28
    v_lshrrev_b32 v18, 3, v0
    v_lshl_add_u32 v8, v18, 10, v28
    s_lshl_b32 s3, s34, 7
    v_add_u32 v8, s3, v8
    v_xor_b32 v9, 64, v8
    v_add_u32 v9, 0x2000, v9
    v_lshl_add_u32 v28, v1, 3, v3
    v_lshlrev_b32 v28, 6, v28
    v_and_b32 v18, 1, v1
    v_lshl_add_u32 v28, v18, 5, v28
    v_lshl_add_u32 v28, v4, 3, v28
    s_add_u32 s3, s7, 12288
    v_add_u32 v14, s3, v28
    v_xor_b32 v15, 32, v14
    v_lshrrev_b32 v28, 1, v3
    v_lshl_or_b32 v28, v18, 1, v28
    v_lshlrev_b32 v28, 5, v28
    v_lshl_add_u32 v18, v1, 3, v3
    v_lshl_add_u32 v28, v18, 7, v28
    v_lshl_add_u32 v28, v4, 3, v28
    v_add_u32 v24, s7, v28
    v_xor_b32 v25, 32, v24
    v_xor_b32 v26, 64, v24
    v_xor_b32 v27, 96, v24
    s_waitcnt lgkmcnt(0)
    s_add_u32 s76, s76, 1
    s_and_b32 s3, s76, 2
    s_lshl_b32 s3, s3, 15
    s_and_b32 s13, s76, 1
    s_or_b32 s3, s3, s13
    v_mov_b32 v30, s3
    v_mov_b32 v31, s76
    s_lshl_b32 s3, s34, 10
    s_add_u32 s3, s3, 131072
    v_lshlrev_b32 v28, 7, v5
    v_bfe_u32 v18, v0, 3, 1
    v_lshl_add_u32 v28, v18, 6, v28
    v_lshl_add_u32 v28, v1, 4, v28
    v_add_u32 v28, s3, v28
    s_waitcnt vmcnt(10)
    ds_read_b64_tr_b16 v[192:193], v14 offset:0
    ds_read_b64_tr_b16 v[194:195], v14 offset:256
    ds_read_b64_tr_b16 v[196:197], v15 offset:0
    ds_read_b64_tr_b16 v[198:199], v15 offset:256
    ds_read_b64_tr_b16 v[200:201], v14 offset:2048
    ds_read_b64_tr_b16 v[202:203], v14 offset:2304
    ds_read_b64_tr_b16 v[204:205], v15 offset:2048
    ds_read_b64_tr_b16 v[206:207], v15 offset:2304
    s_waitcnt lgkmcnt(6)
    v_mfma_f32_16x16x32_bf16 v[48:51], v[192:195], v[32:35], 0
    s_waitcnt lgkmcnt(4)
    v_mfma_f32_16x16x32_bf16 v[52:55], v[196:199], v[32:35], 0
    s_waitcnt lgkmcnt(2)
    v_mfma_f32_16x16x32_bf16 v[48:51], v[200:203], v[36:39], v[48:51]
    s_waitcnt lgkmcnt(0)
    v_mfma_f32_16x16x32_bf16 v[52:55], v[204:207], v[36:39], v[52:55]
    s_nop 7
    v_cndmask_b32 v56, v48, v52, s[78:79]
    v_cndmask_b32 v57, v49, v53, s[78:79]
    v_cndmask_b32 v58, v50, v54, s[78:79]
    v_cndmask_b32 v59, v51, v55, s[78:79]
    ds_write_b128 v28, v[56:59]
    s_waitcnt lgkmcnt(0)
    s_barrier
    s_cmp_lg_u32 s34, 0
    s_cbranch_scc1 SKIP_11
    v_add_u32 v28, 131072, v29
    ds_read_b128 v[192:195], v28 offset:0
    ds_read_b128 v[196:199], v28 offset:1024
    ds_read_b128 v[200:203], v28 offset:2048
    ds_read_b128 v[204:207], v28 offset:3072
    ds_read_b128 v[208:211], v28 offset:4096
    ds_read_b128 v[212:215], v28 offset:5120
    ds_read_b128 v[216:219], v28 offset:6144
    ds_read_b128 v[220:223], v28 offset:7168
    s_lshl_b32 s3, s4, 6
    s_add_u32 s3, s3, 327680
    v_lshrrev_b32 v28, 3, v0
    v_lshlrev_b32 v28, 13, v28
    v_lshl_add_u32 v28, v5, 3, v28
    s_waitcnt lgkmcnt(0)
    v_pk_add_f32 v[192:193], v[192:193], v[208:209]
    v_pk_add_f32 v[194:195], v[194:195], v[210:211]
    v_pk_add_f32 v[196:197], v[196:197], v[212:213]
    v_pk_add_f32 v[198:199], v[198:199], v[214:215]
    v_pk_add_f32 v[200:201], v[200:201], v[216:217]
    v_pk_add_f32 v[202:203], v[202:203], v[218:219]
    v_pk_add_f32 v[204:205], v[204:205], v[220:221]
    v_pk_add_f32 v[206:207], v[206:207], v[222:223]
    v_pk_add_f32 v[192:193], v[192:193], v[200:201]
    v_pk_add_f32 v[194:195], v[194:195], v[202:203]
    v_pk_add_f32 v[196:197], v[196:197], v[204:205]
    v_pk_add_f32 v[198:199], v[198:199], v[206:207]
    v_pk_add_f32 v[192:193], v[192:193], v[196:197]
    v_pk_add_f32 v[194:195], v[194:195], v[198:199]
    v_perm_b32 v192, v193, v192, s99
    v_bfi_b32 v192, s100, v30, v192
    v_perm_b32 v193, v195, v194, s99
    v_bfi_b32 v193, s100, v30, v193
    buffer_store_dwordx2 v[192:193], v28, s[40:43], s3 offen sc1
SKIP_11:
    s_waitcnt vmcnt(4)
    buffer_load_dwordx4 v[96:99], v13, s[52:55], s9 offen offset:0 nt
    s_waitcnt vmcnt(4)
    buffer_load_dwordx4 v[100:103], v13, s[52:55], s9 offen offset:128 nt
    s_waitcnt vmcnt(4)
    buffer_load_dwordx4 v[104:107], v13, s[52:55], s9 offen offset:2048 nt
    s_waitcnt vmcnt(4)
    buffer_load_dwordx4 v[108:111], v13, s[52:55], s9 offen offset:2176 nt
    v_lshlrev_b32 v18, 16, v40
    v_lshlrev_b32 v19, 16, v44
    v_and_b32 v20, 0xffff0000, v40
    v_and_b32 v21, 0xffff0000, v44
    v_mul_f32 v18, v18, v19
    v_mul_f32 v20, v20, v21
    v_cvt_pk_bf16_f32 v18, v18, v20
    v_lshlrev_b32 v19, 16, v18
    v_and_b32 v20, 0xffff0000, v18
    v_add_f32 v16, v19, v20
    v_lshlrev_b32 v18, 16, v41
    v_lshlrev_b32 v19, 16, v45
    v_and_b32 v20, 0xffff0000, v41
    v_and_b32 v21, 0xffff0000, v45
    v_mul_f32 v18, v18, v19
    v_mul_f32 v20, v20, v21
    v_cvt_pk_bf16_f32 v18, v18, v20
    v_lshlrev_b32 v19, 16, v18
    v_and_b32 v20, 0xffff0000, v18
    v_add_f32 v19, v19, v20
    v_add_f32 v16, v16, v19
    v_lshlrev_b32 v18, 16, v42
    v_lshlrev_b32 v19, 16, v46
    v_and_b32 v20, 0xffff0000, v42
    v_and_b32 v21, 0xffff0000, v46
    v_mul_f32 v18, v18, v19
    v_mul_f32 v20, v20, v21
    v_cvt_pk_bf16_f32 v18, v18, v20
    v_lshlrev_b32 v19, 16, v18
    v_and_b32 v20, 0xffff0000, v18
    v_add_f32 v19, v19, v20
    v_add_f32 v16, v16, v19
    v_lshlrev_b32 v18, 16, v43
    v_lshlrev_b32 v19, 16, v47
    v_and_b32 v20, 0xffff0000, v43
    v_and_b32 v21, 0xffff0000, v47
    v_mul_f32 v18, v18, v19
    v_mul_f32 v20, v20, v21
    v_cvt_pk_bf16_f32 v18, v18, v20
    v_lshlrev_b32 v19, 16, v18
    v_and_b32 v20, 0xffff0000, v18
    v_add_f32 v19, v19, v20
    v_add_f32 v16, v16, v19
    s_nop 1
    v_add_f32_dpp v16, v16, v16 row_ror:8 row_mask:0xf bank_mask:0xf
    s_nop 1
    v_add_f32_dpp v16, v16, v16 row_ror:4 row_mask:0xf bank_mask:0xf
    s_nop 1
    v_add_f32_dpp v16, v16, v16 row_ror:2 row_mask:0xf bank_mask:0xf
    s_nop 1
    v_add_f32_dpp v16, v16, v16 row_ror:1 row_mask:0xf bank_mask:0xf
    v_mov_b32 v18, v16
    s_nop 1
    v_permlane32_swap_b32 v16, v18
    v_add_f32 v16, v16, v18
    v_mov_b32 v18, v16
    s_nop 1
    v_permlane16_swap_b32 v16, v18
    v_add_f32 v16, v16, v18
    v_cvt_pk_bf16_f32 v16, v16, v16
    v_lshlrev_b32 v16, 16, v16
    v_mul_f32 v16, 0xbfb8aa3b, v16
    v_exp_f32 v16, v16
    s_nop 0
    v_add_f32 v16, 1.0, v16
    v_rcp_f32 v16, v16
    s_nop 0
    v_cvt_pk_bf16_f32 v16, v16, v16
    v_lshlrev_b32 v16, 16, v16
    v_sub_f32 v17, 1.0, v16
    v_cvt_pk_bf16_f32 v17, v17, v17
    v_lshlrev_b32 v17, 16, v17
    s_lshl_b32 s11, s35, 13
    s_lshl_b32 s3, s5, 10
    s_add_u32 s11, s11, s3
    s_add_u32 s11, s11, 327680
    v_bfe_u32 v7, v0, 2, 1
    v_lshlrev_b32 v7, 6, v7
    v_lshl_add_u32 v7, v4, 8, v7
    v_lshl_add_u32 v7, v1, 4, v7
    s_add_u32 s3, s38, 0
    s_and_b32 s3, s3, 3
    s_lshl_b32 s12, s3, 15
    s_add_u32 s3, s38, 1
    s_and_b32 s3, s3, 3
    s_lshl_b32 s13, s3, 15
    s_add_u32 s3, s38, 2
    s_and_b32 s3, s3, 3
    s_lshl_b32 s14, s3, 15
    s_add_u32 s3, s38, 3
    s_and_b32 s3, s3, 3
    s_lshl_b32 s15, s3, 15
    s_waitcnt vmcnt(4)
    s_barrier
    buffer_load_dwordx4 v[32:35], v7, s[40:43], s11 offen offset:0 sc1
    buffer_load_dwordx4 v[36:39], v7, s[40:43], s11 offen offset:128 sc1
    s_waitcnt vmcnt(4)
    s_barrier
    buffer_load_dwordx4 v[112:115], v13, s[52:55], s10 offen offset:0 nt
    s_waitcnt vmcnt(4)
    buffer_load_dwordx4 v[116:119], v13, s[52:55], s10 offen offset:128 nt
    s_waitcnt vmcnt(4)
    buffer_load_dwordx4 v[120:123], v13, s[52:55], s10 offen offset:2048 nt
    s_waitcnt vmcnt(4)
    buffer_load_dwordx4 v[124:127], v13, s[52:55], s10 offen offset:2176 nt
    s_waitcnt vmcnt(4)
    s_barrier
    buffer_load_dwordx4 v[128:131], v6, s[56:59], 0 offen offset:0 nt
    s_waitcnt vmcnt(4)
    buffer_load_dwordx4 v[132:135], v6, s[56:59], 0 offen offset:256 nt
    s_waitcnt vmcnt(4)
    buffer_load_dwordx4 v[136:139], v6, s[56:59], 0 offen offset:512 nt
    s_waitcnt vmcnt(4)
    buffer_load_dwordx4 v[140:143], v6, s[56:59], 0 offen offset:768 nt
    s_waitcnt vmcnt(4)
    s_barrier
    buffer_load_dwordx4 v[144:147], v6, s[56:59], s8 offen offset:0 nt
    s_waitcnt vmcnt(4)
    buffer_load_dwordx4 v[148:151], v6, s[56:59], s8 offen offset:256 nt
    s_waitcnt vmcnt(4)
    buffer_load_dwordx4 v[152:155], v6, s[56:59], s8 offen offset:512 nt
    s_waitcnt vmcnt(4)
    buffer_load_dwordx4 v[156:159], v6, s[56:59], s8 offen offset:768 nt
CHK_12:
    v_bitop3_b32 v48, v32, v33, v30 bitop3:0x7e
    v_bitop3_b32 v49, v34, v35, v30 bitop3:0x7e
    v_bitop3_b32 v50, v36, v37, v30 bitop3:0x7e
    v_or3_b32 v48, v48, v49, v50
    v_bitop3_b32 v49, v38, v39, v30 bitop3:0x7e
    v_or_b32 v48, v48, v49
    v_and_b32 v48, s100, v48
    v_cmp_ne_u32 vcc, 0, v48
    s_nop 0
    s_cbranch_vccz DONE_13
    s_cmp_eq_u32 s77, 0
    s_cbranch_scc1 DONE_13
    s_sub_u32 s77, s77, 1
    buffer_load_dwordx4 v[32:35], v7, s[40:43], s11 offen offset:0 sc1
    buffer_load_dwordx4 v[36:39], v7, s[40:43], s11 offen offset:128 sc1
    s_waitcnt vmcnt(0)
    s_branch CHK_12
DONE_13:
    v_or_b32 v32, s100, v32
    v_or_b32 v33, s100, v33
    v_or_b32 v34, s100, v34
    v_or_b32 v35, s100, v35
    v_or_b32 v36, s100, v36
    v_or_b32 v37, s100, v37
    v_or_b32 v38, s100, v38
    v_or_b32 v39, s100, v39
    v_mfma_f32_16x16x32_bf16 v[192:195], v[64:67], v[32:35], 0
    v_mfma_f32_16x16x32_bf16 v[196:199], v[72:75], v[32:35], 0
    v_mfma_f32_16x16x32_bf16 v[200:203], v[80:83], v[32:35], 0
    v_mfma_f32_16x16x32_bf16 v[204:207], v[88:91], v[32:35], 0
    v_mfma_f32_16x16x32_bf16 v[208:211], v[96:99], v[32:35], 0
    v_mfma_f32_16x16x32_bf16 v[212:215], v[104:107], v[32:35], 0
    v_mfma_f32_16x16x32_bf16 v[216:219], v[112:115], v[32:35], 0
    v_mfma_f32_16x16x32_bf16 v[220:223], v[120:123], v[32:35], 0
    v_mfma_f32_16x16x32_bf16 v[192:195], v[68:71], v[36:39], v[192:195]
    v_mfma_f32_16x16x32_bf16 v[196:199], v[76:79], v[36:39], v[196:199]
    v_mfma_f32_16x16x32_bf16 v[200:203], v[84:87], v[36:39], v[200:203]
    v_mfma_f32_16x16x32_bf16 v[204:207], v[92:95], v[36:39], v[204:207]
    v_mfma_f32_16x16x32_bf16 v[208:211], v[100:103], v[36:39], v[208:211]
    v_mfma_f32_16x16x32_bf16 v[212:215], v[108:111], v[36:39], v[212:215]
    v_mfma_f32_16x16x32_bf16 v[216:219], v[116:119], v[36:39], v[216:219]
    v_mfma_f32_16x16x32_bf16 v[220:223], v[124:127], v[36:39], v[220:223]
    s_nop 1
    v_permlane32_swap_b32 v192, v196
    v_permlane32_swap_b32 v193, v197
    v_permlane32_swap_b32 v194, v198
    v_permlane32_swap_b32 v195, v199
    v_permlane32_swap_b32 v200, v204
    v_permlane32_swap_b32 v201, v205
    v_permlane32_swap_b32 v202, v206
    v_permlane32_swap_b32 v203, v207
    v_permlane32_swap_b32 v208, v212
    v_permlane32_swap_b32 v209, v213
    v_permlane32_swap_b32 v210, v214
    v_permlane32_swap_b32 v211, v215
    v_permlane32_swap_b32 v216, v220
    v_permlane32_swap_b32 v217, v221
    v_permlane32_swap_b32 v218, v222
    v_permlane32_swap_b32 v219, v223
    v_add_f32_dpp v48, v196, v192 row_ror:4 row_mask:0xf bank_mask:0xf
    v_add_f32_dpp v49, v197, v193 row_ror:4 row_mask:0xf bank_mask:0xf
    v_add_f32_dpp v50, v198, v194 row_ror:4 row_mask:0xf bank_mask:0xf
    v_add_f32_dpp v51, v199, v195 row_ror:4 row_mask:0xf bank_mask:0xf
    v_add_f32_dpp v52, v204, v200 row_ror:4 row_mask:0xf bank_mask:0xf
    v_add_f32_dpp v53, v205, v201 row_ror:4 row_mask:0xf bank_mask:0xf
    v_add_f32_dpp v54, v206, v202 row_ror:4 row_mask:0xf bank_mask:0xf
    v_add_f32_dpp v55, v207, v203 row_ror:4 row_mask:0xf bank_mask:0xf
    v_add_f32_dpp v56, v212, v208 row_ror:4 row_mask:0xf bank_mask:0xf
    v_add_f32_dpp v57, v213, v209 row_ror:4 row_mask:0xf bank_mask:0xf
    v_add_f32_dpp v58, v214, v210 row_ror:4 row_mask:0xf bank_mask:0xf
    v_add_f32_dpp v59, v215, v211 row_ror:4 row_mask:0xf bank_mask:0xf
    v_add_f32_dpp v60, v220, v216 row_ror:4 row_mask:0xf bank_mask:0xf
    v_add_f32_dpp v61, v221, v217 row_ror:4 row_mask:0xf bank_mask:0xf
    v_add_f32_dpp v62, v222, v218 row_ror:4 row_mask:0xf bank_mask:0xf
    v_add_f32_dpp v63, v223, v219 row_ror:4 row_mask:0xf bank_mask:0xf
    v_max3_f32 v18, v48, v49, v50
    v_max3_f32 v18, v18, v51, v52
    v_max3_f32 v18, v18, v53, v54
    v_max3_f32 v18, v18, v55, v56
    v_max3_f32 v18, v18, v57, v58
    v_max3_f32 v18, v18, v59, v60
    v_max3_f32 v18, v18, v61, v62
    v_max_f32 v18, v18, v63
    v_mov_b32 v19, v18
    s_nop 1
    v_permlane32_swap_b32 v18, v19
    v_max_f32 v18, v18, v19
    v_mov_b32 v19, v18
    s_nop 1
    v_permlane16_swap_b32 v18, v19
    v_max_f32 v18, v18, v19
    v_mov_b32 v19, 0x3e0293ee
    v_mul_f32 v18, v18, v19
    v_fma_f32 v48, v48, v19, -v18
    v_fma_f32 v49, v49, v19, -v18
    v_fma_f32 v50, v50, v19, -v18
    v_fma_f32 v51, v51, v19, -v18
    v_fma_f32 v52, v52, v19, -v18
    v_fma_f32 v53, v53, v19, -v18
    v_fma_f32 v54, v54, v19, -v18
    v_fma_f32 v55, v55, v19, -v18
    v_fma_f32 v56, v56, v19, -v18
    v_fma_f32 v57, v57, v19, -v18
    v_fma_f32 v58, v58, v19, -v18
    v_fma_f32 v59, v59, v19, -v18
    v_fma_f32 v60, v60, v19, -v18
    v_fma_f32 v61, v61, v19, -v18
    v_fma_f32 v62, v62, v19, -v18
    v_fma_f32 v63, v63, v19, -v18
    v_exp_f32 v48, v48
    v_exp_f32 v49, v49
    v_exp_f32 v50, v50
    v_exp_f32 v51, v51
    v_exp_f32 v52, v52
    v_exp_f32 v53, v53
    v_exp_f32 v54, v54
    v_exp_f32 v55, v55
    v_exp_f32 v56, v56
    v_exp_f32 v57, v57
    v_exp_f32 v58, v58
    v_exp_f32 v59, v59
    v_exp_f32 v60, v60
    v_exp_f32 v61, v61
    v_exp_f32 v62, v62
    v_exp_f32 v63, v63
    v_cvt_pk_bf16_f32 v32, v48, v49
    v_cvt_pk_bf16_f32 v33, v50, v51
    v_cvt_pk_bf16_f32 v34, v52, v53
    v_cvt_pk_bf16_f32 v35, v54, v55
    v_cvt_pk_bf16_f32 v36, v56, v57
    v_cvt_pk_bf16_f32 v37, v58, v59
    v_cvt_pk_bf16_f32 v38, v60, v61
    v_cvt_pk_bf16_f32 v39, v62, v63
    v_pk_add_f32 v[48:49], v[48:49], v[56:57]
    v_pk_add_f32 v[50:51], v[50:51], v[58:59]
    v_pk_add_f32 v[52:53], v[52:53], v[60:61]
    v_pk_add_f32 v[54:55], v[54:55], v[62:63]
    v_pk_add_f32 v[48:49], v[48:49], v[52:53]
    v_pk_add_f32 v[50:51], v[50:51], v[54:55]
    v_pk_add_f32 v[48:49], v[48:49], v[50:51]
    v_add_f32 v19, v48, v49
    v_mov_b32 v20, v19
    s_nop 1
    v_permlane32_swap_b32 v19, v20
    v_add_f32 v19, v19, v20
    v_mov_b32 v20, v19
    s_nop 1
    v_permlane16_swap_b32 v19, v20
    v_add_f32 v19, v19, v20
    s_lshl_b32 s3, s34, 2
    s_add_u32 s3, s3, 151552
    v_lshl_add_u32 v20, v4, 6, s3
    s_mov_b64 exec, 15
    ds_write_b32 v20, v18
    ds_write_b32 v20, v19 offset:32
    s_mov_b64 exec, -1
    s_waitcnt vmcnt(4)
    s_barrier
    s_mov_b32 s3, s12
    s_add_u32 m0, s7, 4096
    s_nop 0
    buffer_load_dwordx4 v8, s[64:67], s3 offen nt lds
    s_add_u32 m0, m0, 1024
    s_waitcnt vmcnt(4)
    buffer_load_dwordx4 v9, s[64:67], s3 offen nt lds
    s_add_u32 m0, m0, 1024
    s_add_u32 s3, s3, 0x4000
    s_waitcnt vmcnt(4)
    buffer_load_dwordx4 v8, s[64:67], s3 offen nt lds
    s_add_u32 m0, m0, 1024
    s_waitcnt vmcnt(4)
    buffer_load_dwordx4 v9, s[64:67], s3 offen nt lds
    v_perm_b32 v192, v132, v128, s98
    v_perm_b32 v196, v132, v128, s99
    v_perm_b32 v193, v140, v136, s98
    v_perm_b32 v197, v140, v136, s99
    v_perm_b32 v200, v133, v129, s98
    v_perm_b32 v204, v133, v129, s99
    v_perm_b32 v201, v141, v137, s98
    v_perm_b32 v205, v141, v137, s99
    v_perm_b32 v208, v134, v130, s98
    v_perm_b32 v212, v134, v130, s99
    v_perm_b32 v209, v142, v138, s98
    v_perm_b32 v213, v142, v138, s99
    v_perm_b32 v216, v135, v131, s98
    v_perm_b32 v220, v135, v131, s99
    v_perm_b32 v217, v143, v139, s98
    v_perm_b32 v221, v143, v139, s99
    s_waitcnt vmcnt(4)
    s_barrier
    s_mov_b32 s3, s13
    s_add_u32 m0, s7, 8192
    s_nop 0
    buffer_load_dwordx4 v8, s[64:67], s3 offen nt lds
    s_add_u32 m0, m0, 1024
    s_waitcnt vmcnt(4)
    buffer_load_dwordx4 v9, s[64:67], s3 offen nt lds
    s_add_u32 m0, m0, 1024
    s_add_u32 s3, s3, 0x4000
    s_waitcnt vmcnt(4)
    buffer_load_dwordx4 v8, s[64:67], s3 offen nt lds
    s_add_u32 m0, m0, 1024
    s_waitcnt vmcnt(4)
    buffer_load_dwordx4 v9, s[64:67], s3 offen nt lds
    v_perm_b32 v194, v148, v144, s98
    v_perm_b32 v198, v148, v144, s99
    v_perm_b32 v195, v156, v152, s98
    v_perm_b32 v199, v156, v152, s99
    v_perm_b32 v202, v149, v145, s98
    v_perm_b32 v206, v149, v145, s99
    v_perm_b32 v203, v157, v153, s98
    v_perm_b32 v207, v157, v153, s99
    v_perm_b32 v210, v150, v146, s98
    v_perm_b32 v214, v150, v146, s99
    v_perm_b32 v211, v158, v154, s98
    v_perm_b32 v215, v158, v154, s99
    v_perm_b32 v218, v151, v147, s98
    v_perm_b32 v222, v151, v147, s99
    v_perm_b32 v219, v159, v155, s98
    v_perm_b32 v223, v159, v155, s99
    v_mfma_f32_16x16x32_bf16 v[224:227], v[192:195], v[32:35], 0
    v_mfma_f32_16x16x32_bf16 v[228:231], v[196:199], v[32:35], 0
    v_mfma_f32_16x16x32_bf16 v[232:235], v[200:203], v[32:35], 0
    v_mfma_f32_16x16x32_bf16 v[236:239], v[204:207], v[32:35], 0
    v_mfma_f32_16x16x32_bf16 v[240:243], v[208:211], v[32:35], 0
    v_mfma_f32_16x16x32_bf16 v[244:247], v[212:215], v[32:35], 0
    v_mfma_f32_16x16x32_bf16 v[248:251], v[216:219], v[32:35], 0
    v_mfma_f32_16x16x32_bf16 v[252:255], v[220:223], v[32:35], 0
    s_waitcnt vmcnt(4)
    s_barrier
    s_mov_b32 s3, s14
    s_add_u32 m0, s7, 12288
    s_nop 0
    buffer_load_dwordx4 v8, s[64:67], s3 offen nt lds
    s_add_u32 m0, m0, 1024
    s_waitcnt vmcnt(4)
    buffer_load_dwordx4 v9, s[64:67], s3 offen nt lds
    s_add_u32 m0, m0, 1024
    s_add_u32 s3, s3, 0x4000
    s_waitcnt vmcnt(4)
    buffer_load_dwordx4 v8, s[64:67], s3 offen nt lds
    s_add_u32 m0, m0, 1024
    s_waitcnt vmcnt(4)
    buffer_load_dwordx4 v9, s[64:67], s3 offen nt lds
    ds_read_b64_tr_b16 v[64:65], v24 offset:4096
    ds_read_b64_tr_b16 v[66:67], v24 offset:4608
    ds_read_b64_tr_b16 v[68:69], v25 offset:4096
    ds_read_b64_tr_b16 v[70:71], v25 offset:4608
    ds_read_b64_tr_b16 v[72:73], v26 offset:4096
    ds_read_b64_tr_b16 v[74:75], v26 offset:4608
    ds_read_b64_tr_b16 v[76:77], v27 offset:4096
    ds_read_b64_tr_b16 v[78:79], v27 offset:4608
    s_waitcnt lgkmcnt(0)
    s_waitcnt vmcnt(4)
    s_barrier
    s_mov_b32 s3, s15
    s_add_u32 m0, s7, 4096
    s_nop 0
    buffer_load_dwordx4 v8, s[64:67], s3 offen nt lds
    s_add_u32 m0, m0, 1024
    s_waitcnt vmcnt(4)
    buffer_load_dwordx4 v9, s[64:67], s3 offen nt lds
    s_add_u32 m0, m0, 1024
    s_add_u32 s3, s3, 0x4000
    s_waitcnt vmcnt(4)
    buffer_load_dwordx4 v8, s[64:67], s3 offen nt lds
    s_add_u32 m0, m0, 1024
    s_waitcnt vmcnt(4)
    buffer_load_dwordx4 v9, s[64:67], s3 offen nt lds
    ds_read_b64_tr_b16 v[80:81], v24 offset:8192
    ds_read_b64_tr_b16 v[82:83], v24 offset:8704
    ds_read_b64_tr_b16 v[84:85], v25 offset:8192
    ds_read_b64_tr_b16 v[86:87], v25 offset:8704
    ds_read_b64_tr_b16 v[88:89], v26 offset:8192
    ds_read_b64_tr_b16 v[90:91], v26 offset:8704
    ds_read_b64_tr_b16 v[92:93], v27 offset:8192
    ds_read_b64_tr_b16 v[94:95], v27 offset:8704
    s_waitcnt lgkmcnt(0)
    s_barrier
    buffer_load_dwordx4 v[160:163], v6, s[56:59], s9 offen offset:0 nt
    buffer_load_dwordx4 v[164:167], v6, s[56:59], s9 offen offset:256 nt
    buffer_load_dwordx4 v[168:171], v6, s[56:59], s9 offen offset:512 nt
    s_waitcnt vmcnt(7)
    buffer_load_dwordx4 v[172:175], v6, s[56:59], s9 offen offset:768 nt
    ds_read_b64_tr_b16 v[96:97], v24 offset:12288
    ds_read_b64_tr_b16 v[98:99], v24 offset:12800
    ds_read_b64_tr_b16 v[100:101], v25 offset:12288
    ds_read_b64_tr_b16 v[102:103], v25 offset:12800
    ds_read_b64_tr_b16 v[104:105], v26 offset:12288
    ds_read_b64_tr_b16 v[106:107], v26 offset:12800
    ds_read_b64_tr_b16 v[108:109], v27 offset:12288
    ds_read_b64_tr_b16 v[110:111], v27 offset:12800
    s_waitcnt lgkmcnt(0)
    s_waitcnt vmcnt(7)
    s_barrier
    buffer_load_dwordx4 v[176:179], v6, s[56:59], s10 offen offset:0 nt
    s_waitcnt vmcnt(7)
    buffer_load_dwordx4 v[180:183], v6, s[56:59], s10 offen offset:256 nt
    s_waitcnt vmcnt(7)
    buffer_load_dwordx4 v[184:187], v6, s[56:59], s10 offen offset:512 nt
    s_waitcnt vmcnt(7)
    buffer_load_dwordx4 v[188:191], v6, s[56:59], s10 offen offset:768 nt
    ds_read_b64_tr_b16 v[112:113], v24 offset:4096
    ds_read_b64_tr_b16 v[114:115], v24 offset:4608
    ds_read_b64_tr_b16 v[116:117], v25 offset:4096
    ds_read_b64_tr_b16 v[118:119], v25 offset:4608
    ds_read_b64_tr_b16 v[120:121], v26 offset:4096
    ds_read_b64_tr_b16 v[122:123], v26 offset:4608
    ds_read_b64_tr_b16 v[124:125], v27 offset:4096
    ds_read_b64_tr_b16 v[126:127], v27 offset:4608
    s_waitcnt lgkmcnt(0)
    s_waitcnt vmcnt(7)
    s_barrier
    s_lshl_b32 s3, s34, 17
    s_mov_b32 m0, s7
    s_nop 0
    buffer_load_dwordx4 v10, s[60:63], s3 offen nt lds
    s_add_u32 m0, m0, 1024
    s_add_u32 s3, s3, 0x8000
    s_waitcnt vmcnt(7)
    buffer_load_dwordx4 v10, s[60:63], s3 offen nt lds
    s_add_u32 m0, m0, 1024
    s_add_u32 s3, s3, 0x8000
    s_waitcnt vmcnt(7)
    buffer_load_dwordx4 v11, s[60:63], s3 offen nt lds
    s_add_u32 m0, m0, 1024
    s_add_u32 s3, s3, 0x8000
    s_waitcnt vmcnt(7)
    buffer_load_dwordx4 v11, s[60:63], s3 offen nt lds
    v_perm_b32 v192, v164, v160, s98
    v_perm_b32 v196, v164, v160, s99
    v_perm_b32 v193, v172, v168, s98
    v_perm_b32 v197, v172, v168, s99
    v_perm_b32 v200, v165, v161, s98
    v_perm_b32 v204, v165, v161, s99
    v_perm_b32 v201, v173, v169, s98
    v_perm_b32 v205, v173, v169, s99
    v_perm_b32 v208, v166, v162, s98
    v_perm_b32 v212, v166, v162, s99
    v_perm_b32 v209, v174, v170, s98
    v_perm_b32 v213, v174, v170, s99
    v_perm_b32 v216, v167, v163, s98
    v_perm_b32 v220, v167, v163, s99
    v_perm_b32 v217, v175, v171, s98
    v_perm_b32 v221, v175, v171, s99
    s_waitcnt vmcnt(7)
    s_barrier
    s_mov_b32 s3, 0
    s_add_u32 m0, s7, 8192
    s_nop 0
    buffer_load_dwordx4 v8, s[68:71], s3 offen nt lds
    s_add_u32 m0, m0, 1024
    s_waitcnt vmcnt(7)
    buffer_load_dwordx4 v9, s[68:71], s3 offen nt lds
    s_add_u32 m0, m0, 1024
    s_add_u32 s3, s3, 0x4000
    s_waitcnt vmcnt(7)
    buffer_load_dwordx4 v8, s[68:71], s3 offen nt lds
    s_add_u32 m0, m0, 1024
    s_waitcnt vmcnt(7)
    buffer_load_dwordx4 v9, s[68:71], s3 offen nt lds
    v_perm_b32 v194, v180, v176, s98
    v_perm_b32 v198, v180, v176, s99
    v_perm_b32 v195, v188, v184, s98
    v_perm_b32 v199, v188, v184, s99
    v_perm_b32 v202, v181, v177, s98
    v_perm_b32 v206, v181, v177, s99
    v_perm_b32 v203, v189, v185, s98
    v_perm_b32 v207, v189, v185, s99
    v_perm_b32 v210, v182, v178, s98
    v_perm_b32 v214, v182, v178, s99
    v_perm_b32 v211, v190, v186, s98
    v_perm_b32 v215, v190, v186, s99
    v_perm_b32 v218, v183, v179, s98
    v_perm_b32 v222, v183, v179, s99
    v_perm_b32 v219, v191, v187, s98
    v_perm_b32 v223, v191, v187, s99
    v_mfma_f32_16x16x32_bf16 v[224:227], v[192:195], v[36:39], v[224:227]
    v_mfma_f32_16x16x32_bf16 v[228:231], v[196:199], v[36:39], v[228:231]
    v_mfma_f32_16x16x32_bf16 v[232:235], v[200:203], v[36:39], v[232:235]
    v_mfma_f32_16x16x32_bf16 v[236:239], v[204:207], v[36:39], v[236:239]
    v_mfma_f32_16x16x32_bf16 v[240:243], v[208:211], v[36:39], v[240:243]
    v_mfma_f32_16x16x32_bf16 v[244:247], v[212:215], v[36:39], v[244:247]
    v_mfma_f32_16x16x32_bf16 v[248:251], v[216:219], v[36:39], v[248:251]
    v_mfma_f32_16x16x32_bf16 v[252:255], v[220:223], v[36:39], v[252:255]
    s_mul_i32 s3, s34, 2560
    s_add_u32 s3, s3, 131072
    v_mul_u32_u24 v18, 640, v4
    v_lshl_add_u32 v18, v1, 4, v18
    v_add_u32 v18, s3, v18
    s_mov_b32 exec_lo, 0x000f000f
    s_mov_b32 exec_hi, 0x000f000f
    ds_write_b128 v18, v[224:227] offset:0
    ds_write_b128 v18, v[228:231] offset:80
    ds_write_b128 v18, v[232:235] offset:160
    ds_write_b128 v18, v[236:239] offset:240
    ds_write_b128 v18, v[240:243] offset:320
    ds_write_b128 v18, v[244:247] offset:400
    ds_write_b128 v18, v[248:251] offset:480
    ds_write_b128 v18, v[252:255] offset:560
    s_mov_b64 exec, -1
    s_lshr_b32 s16, s34, 1
    s_and_b32 s17, s34, 1
    s_mul_i32 s3, s16, 640
    s_lshl_b32 s18, s17, 5
    s_add_u32 s3, s3, s18
    s_add_u32 s3, s3, 131072
    v_mul_u32_u24 v18, 80, v5
    v_lshrrev_b32 v19, 3, v0
    v_lshl_add_u32 v18, v19, 2, v18
    v_add_u32 v18, s3, v18
    s_lshl_b32 s3, s16, 6
    s_add_u32 s3, s3, 151552
    v_mov_b32 v19, s3
    s_waitcnt lgkmcnt(0)
    s_barrier
    ds_read_b128 v[192:195], v19 offset:0
    ds_read_b128 v[196:199], v19 offset:16
    ds_read_b128 v[200:203], v19 offset:32
    ds_read_b128 v[204:207], v19 offset:48
    ds_read_b32 v208, v18 offset:0
    ds_read_b32 v209, v18 offset:2560
    ds_read_b32 v210, v18 offset:5120
    ds_read_b32 v211, v18 offset:7680
    ds_read_b32 v212, v18 offset:10240
    ds_read_b32 v213, v18 offset:12800
    ds_read_b32 v214, v18 offset:15360
    ds_read_b32 v215, v18 offset:17920
    s_lshl_b32 s3, s5, 2
    s_add_u32 s3, s3, s16
    s_lshl_b32 s18, s3, 13
    s_lshl_b32 s19, s17, 12
    s_add_u32 s18, s18, s19
    s_lshl_b32 s19, s35, 8
    s_add_u32 s18, s18, s19
    s_lshl_b32 s19, s6, 7
    s_add_u32 s18, s18, s19
    s_add_u32 s18, s18, 7340032
    s_lshl_b32 s3, s3, 7
    s_lshl_b32 s19, s35, 4
    s_add_u32 s3, s3, s19
    s_lshl_b32 s19, s6, 3
    s_add_u32 s3, s3, s19
    s_add_u32 s19, s3, 7634944
    v_lshrrev_b32 v20, 5, v0
    v_and_b32 v21, 31, v0
    v_lshlrev_b32 v21, 2, v21
    v_lshl_add_u32 v20, v20, 11, v21
    s_waitcnt lgkmcnt(8)
    v_max3_f32 v216, v192, v193, v194
    v_max3_f32 v216, v216, v195, v196
    v_max3_f32 v216, v216, v197, v198
    v_max_f32 v216, v216, v199
    v_sub_f32 v192, v192, v216
    v_sub_f32 v193, v193, v216
    v_sub_f32 v194, v194, v216
    v_sub_f32 v195, v195, v216
    v_sub_f32 v196, v196, v216
    v_sub_f32 v197, v197, v216
    v_sub_f32 v198, v198, v216
    v_sub_f32 v199, v199, v216
    v_exp_f32 v192, v192
    v_exp_f32 v193, v193
    v_exp_f32 v194, v194
    v_exp_f32 v195, v195
    v_exp_f32 v196, v196
    v_exp_f32 v197, v197
    v_exp_f32 v198, v198
    v_exp_f32 v199, v199
    v_mul_f32 v217, v192, v200
    v_fma_f32 v217, v193, v201, v217
    v_fma_f32 v217, v194, v202, v217
    v_fma_f32 v217, v195, v203, v217
    v_fma_f32 v217, v196, v204, v217
    v_fma_f32 v217, v197, v205, v217
    v_fma_f32 v217, v198, v206, v217
    v_fma_f32 v217, v199, v207, v217
    s_waitcnt lgkmcnt(0)
    v_mul_f32 v218, v192, v208
    v_fma_f32 v218, v193, v209, v218
    v_fma_f32 v218, v194, v210, v218
    v_fma_f32 v218, v195, v211, v218
    v_fma_f32 v218, v196, v212, v218
    v_fma_f32 v218, v197, v213, v218
    v_fma_f32 v218, v198, v214, v218
    v_fma_f32 v218, v199, v215, v218
    v_rcp_f32 v219, v217
    v_log_f32 v217, v217
    v_mul_f32 v218, v218, v219
    v_add_f32 v216, v217, v216
    v_mov_b32 v219, 0
    v_mov_b32 v217, v31
    v_bfi_b32 v218, s101, v31, v218
    buffer_store_dword v218, v20, s[40:43], s18 offen sc1
    s_mov_b64 exec, 1
    buffer_store_dwordx2 v[216:217], v219, s[40:43], s19 offen sc1
    s_mov_b64 exec, -1
    s_lshl_b32 s18, s4, 11
    s_lshl_b32 s3, s34, 8
    s_add_u32 s18, s18, s3
    s_add_u32 s18, s18, 7340032
    s_lshl_b32 s19, s37, 7
    s_lshl_b32 s3, s34, 4
    s_add_u32 s19, s19, s3
    s_add_u32 s19, s19, 7634944
    v_lshlrev_b32 v18, 2, v0
    v_mov_b32 v19, 0
    s_lshl_b32 s16, s4, 15
    s_lshl_b32 s3, s34, 12
    s_add_u32 s16, s16, s3
    s_add_u32 s16, s16, 3145728
    s_lshl_b32 s17, s37, 10
    s_lshl_b32 s3, s34, 7
    s_add_u32 s17, s17, s3
    s_add_u32 s17, s17, 7602176
    v_lshlrev_b32 v22, 10, v1
    v_lshl_add_u32 v22, v2, 4, v22
    v_lshlrev_b32 v23, 5, v1
    v_lshl_add_u32 v23, v4, 3, v23
    buffer_load_dwordx4 v[192:195], v22, s[40:43], s16 offen offset:0 sc1
    buffer_load_dwordx4 v[196:199], v22, s[40:43], s16 offen offset:256 sc1
    buffer_load_dwordx4 v[200:203], v22, s[40:43], s16 offen offset:512 sc1
    buffer_load_dwordx4 v[204:207], v22, s[40:43], s16 offen offset:768 sc1
    buffer_load_dwordx2 v[212:213], v23, s[40:43], s17 offen sc1
    buffer_load_dword v40, v18, s[40:43], s18 offen sc1
    buffer_load_dwordx4 v[42:45], v19, s[40:43], s19 offen sc1
    s_waitcnt vmcnt(13)
    v_and_b32 v28, 1, v1
    v_lshl_or_b32 v29, v28, 2, v3
    v_xor_b32 v29, s34, v29
    v_lshlrev_b32 v29, 5, v29
    v_lshl_add_u32 v28, v28, 3, v3
    v_lshl_add_u32 v29, v28, 8, v29
    v_lshrrev_b32 v28, 1, v1
    v_lshl_add_u32 v29, v28, 14, v29
    v_lshl_add_u32 v28, v4, 3, v29
    v_add_u32 v29, 0x10000, v28
    s_waitcnt lgkmcnt(0)
    s_barrier
    ds_read_b64_tr_b16 v[144:145], v28 offset:0
    ds_read_b64_tr_b16 v[146:147], v28 offset:1024
    ds_read_b64_tr_b16 v[148:149], v28 offset:32768
    ds_read_b64_tr_b16 v[150:151], v28 offset:33792
    ds_read_b64_tr_b16 v[152:153], v29 offset:0
    ds_read_b64_tr_b16 v[154:155], v29 offset:1024
    ds_read_b64_tr_b16 v[156:157], v29 offset:32768
    ds_read_b64_tr_b16 v[158:159], v29 offset:33792
    s_mul_i32 s3, s34, 288
    s_add_u32 s3, s3, 151808
    v_lshlrev_b32 v230, 4, v2
    v_lshrrev_b32 v231, 1, v1
    v_lshl_add_u32 v230, v231, 3, v230
    v_and_b32 v231, 1, v1
    v_lshl_add_u32 v230, v231, 2, v230
    v_add_u32 v230, s3, v230
    v_mul_u32_u24 v231, 288, v5
    v_lshl_add_u32 v231, v1, 4, v231
    v_add_u32 v231, 151808, v231
    v_mul_u32_u24 v240, 352, v5
    v_lshl_add_u32 v232, v1, 3, v240
    s_lshl_b32 s3, s34, 5
    s_add_u32 s3, s3, 154112
    v_add_u32 v232, s3, v232
    v_lshl_add_u32 v240, v1, 4, v240
    v_add_u32 v240, 154112, v240
    v_lshlrev_b32 v241, 18, v5
    v_bfe_u32 v233, v0, 3, 1
    v_lshl_add_u32 v241, v233, 6, v241
    v_lshl_add_u32 v241, v1, 4, v241
    s_lshl_b32 s20, s34, 15
    s_lshl_b32 s3, s39, 7
    s_add_u32 s20, s20, s3
    s_add_u32 s20, s20, 1048576
    s_add_u32 s21, s20, 16384
    s_mul_i32 s3, s34, 352
    s_add_u32 s3, s3, 154368
    v_and_b32 v242, 31, v0
    v_lshl_add_u32 v242, v242, 1, s3
    v_mov_b32 v243, 0x10000
    s_mov_b32 s22, 0xfffe0000
    s_lshr_b32 s3, s12, 9
    v_add_u32 v236, s3, v240
    s_lshr_b32 s3, s13, 9
    v_add_u32 v237, s3, v240
    s_lshr_b32 s3, s14, 9
    v_add_u32 v238, s3, v240
    s_lshr_b32 s3, s15, 9
    v_add_u32 v239, s3, v240
    s_waitcnt vmcnt(9)
    ds_read_b64_tr_b16 v[128:129], v24 offset:8192
    ds_read_b64_tr_b16 v[130:131], v24 offset:8704
    ds_read_b64_tr_b16 v[132:133], v25 offset:8192
    ds_read_b64_tr_b16 v[134:135], v25 offset:8704
    ds_read_b64_tr_b16 v[136:137], v26 offset:8192
    ds_read_b64_tr_b16 v[138:139], v26 offset:8704
    ds_read_b64_tr_b16 v[140:141], v27 offset:8192
    ds_read_b64_tr_b16 v[142:143], v27 offset:8704
    s_waitcnt lgkmcnt(0)
    s_waitcnt vmcnt(2)
CHK_14:
    v_bitop3_b32 v48, v192, v193, v30 bitop3:0x7e
    v_bitop3_b32 v49, v194, v195, v30 bitop3:0x7e
    v_bitop3_b32 v50, v196, v197, v30 bitop3:0x7e
    v_or3_b32 v48, v48, v49, v50
    v_bitop3_b32 v49, v198, v199, v30 bitop3:0x7e
    v_bitop3_b32 v50, v200, v201, v30 bitop3:0x7e
    v_or3_b32 v48, v48, v49, v50
    v_bitop3_b32 v49, v202, v203, v30 bitop3:0x7e
    v_bitop3_b32 v50, v204, v205, v30 bitop3:0x7e
    v_or3_b32 v48, v48, v49, v50
    v_bitop3_b32 v49, v206, v207, v30 bitop3:0x7e
    v_or_b32 v48, v48, v49
    v_and_b32 v48, s100, v48
    v_bitop3_b32 v49, v213, v213, v31 bitop3:0x7e
    v_or_b32 v48, v48, v49
    v_cmp_ne_u32 vcc, 0, v48
    s_nop 0
    s_cbranch_vccz DONE_15
    s_cmp_eq_u32 s77, 0
    s_cbranch_scc1 DONE_15
    s_sub_u32 s77, s77, 1
    buffer_load_dwordx4 v[192:195], v22, s[40:43], s16 offen offset:0 sc1
    buffer_load_dwordx4 v[196:199], v22, s[40:43], s16 offen offset:256 sc1
    buffer_load_dwordx4 v[200:203], v22, s[40:43], s16 offen offset:512 sc1
    buffer_load_dwordx4 v[204:207], v22, s[40:43], s16 offen offset:768 sc1
    buffer_load_dwordx2 v[212:213], v23, s[40:43], s17 offen sc1
    s_waitcnt vmcnt(0)
    s_branch CHK_14
DONE_15:
    v_max_f32_dpp v213, v212, v212 quad_perm:[1,0,3,2] row_mask:0xf bank_mask:0xf
    s_nop 1
    v_max_f32_dpp v213, v213, v213 quad_perm:[2,3,0,1] row_mask:0xf bank_mask:0xf
    v_mov_b32 v214, v213
    s_nop 1
    v_permlane32_swap_b32 v213, v214
    v_max_f32 v213, v213, v214
    v_mov_b32 v214, v213
    s_nop 1
    v_permlane16_swap_b32 v213, v214
    v_max_f32 v213, v213, v214
    v_sub_f32 v213, v212, v213
    v_exp_f32 v213, v213
    s_nop 1
    v_mov_b32_dpp v208, v213 quad_perm:[0,0,0,0] row_mask:0xf bank_mask:0xf
    v_mov_b32_dpp v209, v213 quad_perm:[1,1,1,1] row_mask:0xf bank_mask:0xf
    v_mov_b32_dpp v210, v213 quad_perm:[2,2,2,2] row_mask:0xf bank_mask:0xf
    v_mov_b32_dpp v211, v213 quad_perm:[3,3,3,3] row_mask:0xf bank_mask:0xf
    v_add_f32 v212, v208, v209
    v_add_f32 v213, v210, v211
    v_add_f32 v212, v212, v213
    v_mov_b32 v213, v212
    s_nop 1
    v_permlane32_swap_b32 v212, v213
    v_add_f32 v212, v212, v213
    v_mov_b32 v213, v212
    s_nop 1
    v_permlane16_swap_b32 v212, v213
    v_add_f32 v212, v212, v213
    v_rcp_f32 v212, v212
    s_nop 0
    v_mul_f32 v212, v212, v16
    v_lshl_or_b32 v214, v192, 16, v243
    v_and_or_b32 v215, v192, s22, v243
    v_lshl_or_b32 v216, v193, 16, v243
    v_and_or_b32 v217, v193, s22, v243
    v_lshl_or_b32 v218, v194, 16, v243
    v_and_or_b32 v219, v194, s22, v243
    v_lshl_or_b32 v220, v195, 16, v243
    v_and_or_b32 v221, v195, s22, v243
    v_mul_f32 v160, v214, v208
    v_mul_f32 v161, v215, v208
    v_mul_f32 v162, v216, v208
    v_mul_f32 v163, v217, v208
    v_mul_f32 v164, v218, v208
    v_mul_f32 v165, v219, v208
    v_mul_f32 v166, v220, v208
    v_mul_f32 v167, v221, v208
    v_lshl_or_b32 v214, v196, 16, v243
    v_and_or_b32 v215, v196, s22, v243
    v_lshl_or_b32 v216, v197, 16, v243
    v_and_or_b32 v217, v197, s22, v243
    v_lshl_or_b32 v218, v198, 16, v243
    v_and_or_b32 v219, v198, s22, v243
    v_lshl_or_b32 v220, v199, 16, v243
    v_and_or_b32 v221, v199, s22, v243
    v_fma_f32 v160, v214, v209, v160
    v_fma_f32 v161, v215, v209, v161
    v_fma_f32 v162, v216, v209, v162
    v_fma_f32 v163, v217, v209, v163
    v_fma_f32 v164, v218, v209, v164
    v_fma_f32 v165, v219, v209, v165
    v_fma_f32 v166, v220, v209, v166
    v_fma_f32 v167, v221, v209, v167
    v_lshl_or_b32 v214, v200, 16, v243
    v_and_or_b32 v215, v200, s22, v243
    v_lshl_or_b32 v216, v201, 16, v243
    v_and_or_b32 v217, v201, s22, v243
    v_lshl_or_b32 v218, v202, 16, v243
    v_and_or_b32 v219, v202, s22, v243
    v_lshl_or_b32 v220, v203, 16, v243
    v_and_or_b32 v221, v203, s22, v243
    v_fma_f32 v160, v214, v210, v160
    v_fma_f32 v161, v215, v210, v161
    v_fma_f32 v162, v216, v210, v162
    v_fma_f32 v163, v217, v210, v163
    v_fma_f32 v164, v218, v210, v164
    v_fma_f32 v165, v219, v210, v165
    v_fma_f32 v166, v220, v210, v166
    v_fma_f32 v167, v221, v210, v167
    v_lshl_or_b32 v214, v204, 16, v243
    v_and_or_b32 v215, v204, s22, v243
    v_lshl_or_b32 v216, v205, 16, v243
    v_and_or_b32 v217, v205, s22, v243
    v_lshl_or_b32 v218, v206, 16, v243
    v_and_or_b32 v219, v206, s22, v243
    v_lshl_or_b32 v220, v207, 16, v243
    v_and_or_b32 v221, v207, s22, v243
    v_fma_f32 v160, v214, v211, v160
    v_fma_f32 v161, v215, v211, v161
    v_fma_f32 v162, v216, v211, v162
    v_fma_f32 v163, v217, v211, v163
    v_fma_f32 v164, v218, v211, v164
    v_fma_f32 v165, v219, v211, v165
    v_fma_f32 v166, v220, v211, v166
    v_fma_f32 v167, v221, v211, v167
    v_permlane32_swap_b32 v160, v164
    v_permlane32_swap_b32 v161, v165
    v_permlane32_swap_b32 v162, v166
    v_permlane32_swap_b32 v163, v167
    v_add_f32 v160, v160, v164
    v_add_f32 v161, v161, v165
    v_add_f32 v162, v162, v166
    v_add_f32 v163, v163, v167
    s_nop 0
    v_permlane16_swap_b32 v160, v162
    v_permlane16_swap_b32 v161, v163
    v_add_f32 v160, v160, v162
    v_add_f32 v161, v161, v163
    v_mul_f32 v160, v160, v212
    v_mul_f32 v161, v161, v212
    v_cvt_pk_bf16_f32 v160, v160, v161
    ds_write_b32 v230, v160
    s_waitcnt lgkmcnt(0)
    s_barrier
    ds_read_b128 v[192:195], v231 offset:0
    ds_read_b128 v[196:199], v231 offset:64
    ds_read_b128 v[200:203], v231 offset:128
    ds_read_b128 v[204:207], v231 offset:192
    s_waitcnt lgkmcnt(3)
    v_mfma_f32_16x16x32_bf16 v[160:163], v[144:147], v[192:195], 0
    s_waitcnt lgkmcnt(2)
    v_mfma_f32_16x16x32_bf16 v[160:163], v[148:151], v[196:199], v[160:163]
    s_waitcnt lgkmcnt(1)
    v_mfma_f32_16x16x32_bf16 v[160:163], v[152:155], v[200:203], v[160:163]
    s_waitcnt lgkmcnt(0)
    v_mfma_f32_16x16x32_bf16 v[160:163], v[156:159], v[204:207], v[160:163]
    s_waitcnt vmcnt(0)
CHK_16:
    v_bitop3_b32 v48, v40, v40, v31 bitop3:0x7e
    v_and_b32 v48, s101, v48
    v_bitop3_b32 v49, v43, v45, v31 bitop3:0x7e
    v_or_b32 v48, v48, v49
    v_cmp_ne_u32 vcc, 0, v48
    s_nop 0
    s_cbranch_vccz DONE_17
    s_cmp_eq_u32 s77, 0
    s_cbranch_scc1 DONE_17
    s_sub_u32 s77, s77, 1
    buffer_load_dword v40, v18, s[40:43], s18 offen sc1
    buffer_load_dwordx4 v[42:45], v19, s[40:43], s19 offen sc1
    s_waitcnt vmcnt(0)
    s_branch CHK_16
DONE_17:
    v_max_f32 v41, v42, v44
    v_sub_f32 v42, v42, v41
    v_sub_f32 v43, v44, v41
    v_exp_f32 v42, v42
    v_exp_f32 v43, v43
    s_nop 0
    v_add_f32 v41, v42, v43
    v_rcp_f32 v41, v41
    v_cmp_gt_u32 vcc, 32, v0
    s_nop 1
    v_cndmask_b32 v42, v43, v42, vcc
    v_mul_f32 v41, v41, v17
    v_mul_f32 v42, v42, v41
    v_mul_f32 v40, v40, v42
    v_mov_b32 v41, v40
    s_nop 1
    v_permlane32_swap_b32 v40, v41
    v_add_f32 v40, v40, v41
    v_cvt_pk_bf16_f32 v40, v40, v40
    ds_write_b16 v242, v40
    v_cvt_pk_bf16_f32 v160, v160, v161
    v_cvt_pk_bf16_f32 v161, v162, v163
    ds_write_b64 v232, v[160:161]
    s_waitcnt lgkmcnt(0)
    s_barrier
    ds_read_b128 v[208:211], v240 offset:256
    ds_read_b128 v[192:195], v236
    ds_read_b128 v[196:199], v237
    ds_read_b128 v[200:203], v238
    ds_read_b128 v[204:207], v239
    s_waitcnt lgkmcnt(4)
    v_mfma_f32_16x16x32_bf16 v[160:163], v[128:131], v[208:211], 0
    v_mfma_f32_16x16x32_bf16 v[164:167], v[132:135], v[208:211], 0
    v_mfma_f32_16x16x32_bf16 v[168:171], v[136:139], v[208:211], 0
    v_mfma_f32_16x16x32_bf16 v[172:175], v[140:143], v[208:211], 0
    s_waitcnt lgkmcnt(3)
    v_mfma_f32_16x16x32_bf16 v[160:163], v[64:67], v[192:195], v[160:163]
    v_mfma_f32_16x16x32_bf16 v[164:167], v[68:71], v[192:195], v[164:167]
    v_mfma_f32_16x16x32_bf16 v[168:171], v[72:75], v[192:195], v[168:171]
    v_mfma_f32_16x16x32_bf16 v[172:175], v[76:79], v[192:195], v[172:175]
    s_waitcnt lgkmcnt(2)
    v_mfma_f32_16x16x32_bf16 v[160:163], v[80:83], v[196:199], v[160:163]
    v_mfma_f32_16x16x32_bf16 v[164:167], v[84:87], v[196:199], v[164:167]
    v_mfma_f32_16x16x32_bf16 v[168:171], v[88:91], v[196:199], v[168:171]
    v_mfma_f32_16x16x32_bf16 v[172:175], v[92:95], v[196:199], v[172:175]
    s_waitcnt lgkmcnt(1)
    v_mfma_f32_16x16x32_bf16 v[160:163], v[96:99], v[200:203], v[160:163]
    v_mfma_f32_16x16x32_bf16 v[164:167], v[100:103], v[200:203], v[164:167]
    v_mfma_f32_16x16x32_bf16 v[168:171], v[104:107], v[200:203], v[168:171]
    v_mfma_f32_16x16x32_bf16 v[172:175], v[108:111], v[200:203], v[172:175]
    s_waitcnt lgkmcnt(0)
    v_mfma_f32_16x16x32_bf16 v[160:163], v[112:115], v[204:207], v[160:163]
    v_mfma_f32_16x16x32_bf16 v[164:167], v[116:119], v[204:207], v[164:167]
    v_mfma_f32_16x16x32_bf16 v[168:171], v[120:123], v[204:207], v[168:171]
    v_mfma_f32_16x16x32_bf16 v[172:175], v[124:127], v[204:207], v[172:175]
    s_nop 5
    v_cndmask_b32 v176, v160, v164, s[78:79]
    v_cndmask_b32 v177, v161, v165, s[78:79]
    v_cndmask_b32 v178, v162, v166, s[78:79]
    v_cndmask_b32 v179, v163, v167, s[78:79]
    v_bfi_b32 v176, s101, v31, v176
    v_bfi_b32 v177, s101, v31, v177
    v_bfi_b32 v178, s101, v31, v178
    v_bfi_b32 v179, s101, v31, v179
    buffer_store_dwordx4 v[176:179], v241, s[40:43], s20 offen sc1
    v_cndmask_b32 v180, v168, v172, s[78:79]
    v_cndmask_b32 v181, v169, v173, s[78:79]
    v_cndmask_b32 v182, v170, v174, s[78:79]
    v_cndmask_b32 v183, v171, v175, s[78:79]
    v_bfi_b32 v180, s101, v31, v180
    v_bfi_b32 v181, s101, v31, v181
    v_bfi_b32 v182, s101, v31, v182
    v_bfi_b32 v183, s101, v31, v183
    buffer_store_dwordx4 v[180:183], v241, s[40:43], s21 offen sc1
    s_endpgm
L_end:
    s_endpgm

.section .rodata,"a"
.p2align 6
.amdhsa_kernel gated_mix__compressed_kv_cla__sliding_block_cached__decode_kernel
  .amdhsa_next_free_vgpr 256
  .amdhsa_next_free_sgpr 102
  .amdhsa_accum_offset 256
  .amdhsa_group_segment_fixed_size 0
  .amdhsa_kernarg_size 120
  .amdhsa_user_sgpr_count 2
  .amdhsa_user_sgpr_kernarg_segment_ptr 1
  .amdhsa_system_sgpr_workgroup_id_x 1
.end_amdhsa_kernel
```
